```python
import torch

def _softmax(x, axis=-1):
    return torch.softmax(x, dim=axis)
def _gelu(x):
    return torch.nn.functional.gelu(x, approximate="tanh")
def _silu(x):
    return torch.nn.functional.silu(x)
def _sigmoid(x):
    return torch.sigmoid(x)
def _layernorm(x, axis=-1, eps=1e-5):
    m = x.mean(dim=axis, keepdim=True)
    v = x.var(dim=axis, keepdim=True, unbiased=False)
    return (x - m) / torch.sqrt(v + eps)
def _scatter_add(tgt, idx, src, axis=0):
    return tgt.clone().index_add_(axis, idx, src)
def _segment_sum(src, seg, n):
    out = torch.zeros((n,) + src.shape[1:], dtype=src.dtype)
    return out.index_add_(0, seg, src)
def _pad(x, pw):
    flat = tuple(v for pair in reversed(pw) for v in pair)
    return torch.nn.functional.pad(x, flat)

kernel_name = 'gated_mix__gqa_block_cached__gqa_block_cached__decode'

def setup_inputs():

    _w = (lambda a: (lambda t: t.to(torch.bfloat16) if t.is_floating_point() else t)(torch.as_tensor(a)))
    def _A_setup():
        B, Sq, D = 4, 1, 1024
        Hq, Hkv, Sk, Dh = 32, 4, 8192, 128
        assert Hq % Hkv == 0, (Hq, Hkv)
        return {
            "x": _w((lambda *s: torch.randn(*s, dtype=torch.bfloat16) * 0.05)(B, Sq, D)),
            "k_cache": _w((lambda *s: torch.randn(*s, dtype=torch.bfloat16) * 6.4)(B, Hkv, Sk, Dh)),
            "v_cache": _w((lambda *s: torch.randn(*s, dtype=torch.bfloat16) * 0.05)(B, Hkv, Sk, Dh)),
            "wq": _w((lambda *s: torch.randn(*s, dtype=torch.bfloat16) * 6.4)(D, Hq * Dh) * (D ** -0.5)),
            "wo": _w((lambda *s: torch.randn(*s, dtype=torch.bfloat16) * 0.05)(Hq * Dh, D) * ((Hq * Dh) ** -0.5)),
        }
    _A_in = _A_setup()

    def _B_setup():
        B, Sq, D = 4, 1, 1024
        Hq, Hkv, Sk, Dh = 32, 4, 8192, 128
        assert Hq % Hkv == 0, (Hq, Hkv)
        return {
            "x": _w((lambda *s: torch.randn(*s, dtype=torch.bfloat16) * 0.05)(B, Sq, D)),
            "k_cache": _w((lambda *s: torch.randn(*s, dtype=torch.bfloat16) * 6.4)(B, Hkv, Sk, Dh)),
            "v_cache": _w((lambda *s: torch.randn(*s, dtype=torch.bfloat16) * 0.05)(B, Hkv, Sk, Dh)),
            "wq": _w((lambda *s: torch.randn(*s, dtype=torch.bfloat16) * 6.4)(D, Hq * Dh) * (D ** -0.5)),
            "wo": _w((lambda *s: torch.randn(*s, dtype=torch.bfloat16) * 0.05)(Hq * Dh, D) * ((Hq * Dh) ** -0.5)),
        }
    _B_in = _B_setup()

    return {
        "A_x": _A_in["x"],
        "A_k_cache": _A_in["k_cache"],
        "A_v_cache": _A_in["v_cache"],
        "A_wq": _A_in["wq"],
        "A_wo": _A_in["wo"],
        "B_x": _B_in["x"],
        "B_k_cache": _B_in["k_cache"],
        "B_v_cache": _B_in["v_cache"],
        "B_wq": _B_in["wq"],
        "B_wo": _B_in["wo"],
        "gate_w": _w((lambda *s: torch.randn(*s, dtype=torch.bfloat16) * 0.05)(1024) * 16.0),
    }

def reference(A_x, A_k_cache, A_v_cache, A_wq, A_wo, B_x, B_k_cache, B_v_cache, B_wq, B_wo, gate_w):
    def _A_ref(x, k_cache, v_cache, wq, wo):
        B, Sq, D = x.shape
        Hq, Dh = 32, 128
        Hkv = k_cache.shape[1]
        rep = Hq // Hkv
        q = (lambda x, *d: x.permute(*d))((x @ wq).reshape(B, Sq, Hq, Dh), 0, 2, 1, 3)
        k = (lambda x, n, axis: torch.repeat_interleave(x, n, dim=axis))(k_cache, rep, axis=1)
        v = (lambda x, n, axis: torch.repeat_interleave(x, n, dim=axis))(v_cache, rep, axis=1)
        scores = torch.einsum("bhqd,bhkd->bhqk", q, k) * (Dh ** -0.5)
        p = _softmax(scores, axis=-1)
        o = torch.einsum("bhqk,bhkd->bhqd", p, v)
        return (lambda x, *d: x.permute(*d))(o, 0, 2, 1, 3).reshape(B, Sq, Hq * Dh) @ wo

    def _B_ref(x, k_cache, v_cache, wq, wo):
        B, Sq, D = x.shape
        Hq, Dh = 32, 128
        Hkv = k_cache.shape[1]
        rep = Hq // Hkv
        q = (lambda x, *d: x.permute(*d))((x @ wq).reshape(B, Sq, Hq, Dh), 0, 2, 1, 3)
        k = (lambda x, n, axis: torch.repeat_interleave(x, n, dim=axis))(k_cache, rep, axis=1)
        v = (lambda x, n, axis: torch.repeat_interleave(x, n, dim=axis))(v_cache, rep, axis=1)
        scores = torch.einsum("bhqd,bhkd->bhqk", q, k) * (Dh ** -0.5)
        p = _softmax(scores, axis=-1)
        o = torch.einsum("bhqk,bhkd->bhqd", p, v)
        return (lambda x, *d: x.permute(*d))(o, 0, 2, 1, 3).reshape(B, Sq, Hq * Dh) @ wo

    x = A_x
    g = _sigmoid((x * gate_w).sum(-1, keepdims=True))
    a = _A_ref(x, A_k_cache, A_v_cache, A_wq, A_wo)
    b = _B_ref(x, B_k_cache, B_v_cache, B_wq, B_wo)
    return g * a + (1 - g) * b
```

```asm
; @launch grid=(256,1,1) block=(512,1,1) lds=55296
.amdgcn_target "amdgcn-amd-amdhsa--gfx950"
.text
.globl gated_mix__gqa_block_cached__gqa_block_cached__decode_kernel
.p2align 8
.type gated_mix__gqa_block_cached__gqa_block_cached__decode_kernel,@function
gated_mix__gqa_block_cached__gqa_block_cached__decode_kernel:
    s_cmp_ge_u32 s2, 256
    s_cbranch_scc1 L_end
    s_load_dwordx16 s[4:19], s[0:1], 0
    s_load_dwordx8 s[20:27], s[0:1], 64
    s_load_dwordx2 s[30:31], s[0:1], 104
    v_lshrrev_b32 v4, 6, v0
    v_mov_b32 v11, v0
    v_readfirstlane_b32 s68, v4
    v_and_b32 v0, 63, v0
    v_lshlrev_b32 v2, 4, v0
    s_getpc_b64 s[44:45]
L_pc:
    s_sub_u32 s44, s44, L_pc-gated_mix__gqa_block_cached__gqa_block_cached__decode_kernel
    s_subb_u32 s45, s45, 0
    s_mov_b32 s46, L_end-gated_mix__gqa_block_cached__gqa_block_cached__decode_kernel+4
    s_mov_b32 s47, 0x00020000
    s_lshl_b32 s76, s68, 11
    buffer_load_dwordx4 v[32:35], v2, s[44:47], s76 offen
    buffer_load_dwordx4 v[36:39], v2, s[44:47], s76 offen offset:1024
    s_and_b32 s69, s2, 7
    s_lshr_b32 s70, s2, 3
    s_lshr_b32 s85, s69, 2
    s_and_b32 s84, s69, 3
    s_lshr_b32 s83, s70, 3
    s_and_b32 s88, s70, 7
    v_lshrrev_b32 v6, 4, v0
    v_and_b32 v7, 15, v0
    v_lshlrev_b32 v7, 4, v7
    v_lshl_or_b32 v6, v6, 16, v7
    s_lshl_b32 s76, s83, 21
    s_lshl_b32 s78, s84, 11
    s_add_u32 s76, s76, s78
    s_lshl_b32 s78, s88, 8
    s_add_u32 s76, s76, s78
    s_sub_u32 s42, 0x800000, s76
    s_mov_b32 s43, 0x00020000
    v_lshrrev_b32 v8, 4, v0
    v_bfe_u32 v9, v0, 1, 1
    v_lshlrev_b32 v1, 10, v9
    v_bfe_u32 v9, v0, 2, 2
    v_lshl_or_b32 v1, v9, 8, v1
    v_lshl_or_b32 v1, v8, 5, v1
    v_and_b32 v9, 1, v0
    v_lshl_or_b32 v1, v9, 4, v1
    s_lshl_b32 s77, s83, 2
    s_add_u32 s77, s77, s84
    s_lshl_b32 s77, s77, 21
    s_lshl_b32 s78, s88, 18
    s_add_u32 s77, s77, s78
    s_mov_b32 s34, 0x40000
    s_mov_b32 s35, 0x00020000
    s_cmp_eq_u32 s85, 0
    s_waitcnt lgkmcnt(0)
    s_cselect_b32 s40, s10, s20
    s_cselect_b32 s41, s11, s21
    s_cselect_b32 s32, s6, s16
    s_cselect_b32 s33, s7, s17
    s_cselect_b32 s36, s8, s18
    s_cselect_b32 s37, s9, s19
    s_cselect_b32 s44, s12, s22
    s_cselect_b32 s45, s13, s23
    s_add_u32 s40, s40, s76
    s_addc_u32 s41, s41, 0
    s_lshl_b32 s80, s68, 18
    s_add_u32 s81, s80, 8192
    buffer_load_dwordx4 v[64:67], v6, s[40:43], s80 offen nt
    buffer_load_dwordx4 v[68:71], v6, s[40:43], s81 offen nt
    s_lshl_b32 s80, s68, 18
    s_add_u32 s80, s80, 16384
    s_add_u32 s81, s80, 8192
    buffer_load_dwordx4 v[72:75], v6, s[40:43], s80 offen nt
    buffer_load_dwordx4 v[76:79], v6, s[40:43], s81 offen nt
    s_lshl_b32 s59, s68, 12
    s_load_dwordx2 s[56:57], s[30:31], 0x0
    s_add_u32 s32, s32, s77
    s_addc_u32 s33, s33, 0
    s_add_u32 s36, s36, s77
    s_addc_u32 s37, s37, 0
    s_mov_b32 s38, 0x40000
    s_mov_b32 s39, 0x00020000
    s_lshr_b32 s89, s70, 3
    s_lshl_b32 s92, s69, 5
    s_add_u32 s92, s92, s70
    s_and_b32 s90, s68, 3
    s_lshr_b32 s91, s68, 2
    s_mov_b32 s48, s4
    s_mov_b32 s49, s5
    s_mov_b32 s50, 8192
    s_mov_b32 s51, 0x00020000
    s_mov_b32 s64, s24
    s_mov_b32 s65, s25
    s_mov_b32 s66, 2048
    s_mov_b32 s67, 0x00020000
    v_and_b32 v7, 3, v0
    v_lshlrev_b32 v7, 11, v7
    v_lshl_or_b32 v7, v8, 4, v7
    s_lshl_b32 s79, s83, 9
    s_lshl_b32 s81, s68, 6
    s_add_u32 s79, s79, s81
    buffer_load_dwordx4 v[16:19], v7, s[48:51], s79 offen
    v_and_b32 v9, 15, v0
    v_lshlrev_b32 v9, 4, v9
    v_lshl_or_b32 v10, v8, 11, v9
    s_lshl_b32 s76, s68, 8
    buffer_load_dwordx4 v[24:27], v10, s[48:51], s76 offen
    buffer_load_dwordx4 v[28:31], v9, s[64:67], s76 offen
    s_mov_b32 s52, s30
    s_mov_b32 s53, s31
    s_mov_b32 s54, 5767168
    s_mov_b32 s55, 0x00020000
    s_lshl_b32 s74, s92, 12
    s_add_u32 s74, s74, 0x100000
    s_lshl_b32 s77, s90, 10
    s_add_u32 s74, s74, s77
    s_mov_b32 s72, 0x05040100
    s_mov_b32 s73, 0x07060302
    s_mov_b32 s93, 0x3db504f3
    s_mov_b32 s94, 0x3fb8aa3b
    v_and_b32 v9, 8, v0
    v_cmp_eq_u32 vcc, 0, v9
    v_mov_b32 v9, 4294901760
    v_mov_b32 v10, 65535
    v_cndmask_b32 v3, v9, v10, vcc
    s_lshl_b32 s78, s84, 3
    s_add_u32 s78, s78, s88
    s_lshl_b32 s78, s78, 18
    s_lshl_b32 s79, s89, 9
    s_add_u32 s78, s78, s79
    s_add_u32 s44, s44, s78
    s_addc_u32 s45, s45, 0
    s_sub_u32 s46, 0x800000, s78
    s_mov_b32 s47, 0x00020000
    s_mov_b32 s60, s26
    s_mov_b32 s61, s27
    s_mov_b32 s62, 8192
    s_mov_b32 s63, 0x00020000
    s_cmp_lg_u32 s68, 0
    s_cbranch_scc1 L_nostlb
    s_load_dword s97, s[32:33], 0
    s_load_dword s97, s[36:37], 0
    s_load_dword s97, s[44:45], 0
    s_load_dword s97, s[60:61], 0
    s_mov_b32 s76, 0x300000
    s_load_dword s97, s[30:31], s76
L_nostlb:
    s_lshl_b32 s58, s69, 16
    s_lshl_b32 s77, s83, 14
    s_add_u32 s58, s58, s77
    s_lshl_b32 s77, s68, 9
    s_add_u32 s58, s58, s77
    s_add_u32 s58, s58, 0x80000
    s_add_u32 s75, s58, 8192
    s_lshl_b32 s76, s69, 12
    s_lshl_b32 s77, s88, 4
    s_add_u32 s76, s76, s77
    s_add_u32 s95, s76, 0x200000
    s_mov_b32 s29, 0xfffff000
    s_mov_b32 s71, 0
    v_mov_b32 v12, 0
    v_mov_b32 v13, 0
    ds_write_b64 v12, v[12:13] offset:34960
    v_mul_u32_u24 v4, 144, v0
    s_mul_i32 s76, s68, 2304
    v_add_u32 v4, s76, v4
    v_and_b32 v5, 15, v0
    v_mul_u32_u24 v7, 4608, v8
    v_lshl_add_u32 v7, v5, 6, v7
    v_lshrrev_b32 v9, 1, v5
    v_lshl_add_u32 v7, v9, 4, v7
    s_and_b32 s76, s68, 1
    s_lshr_b32 s77, s68, 1
    s_mul_i32 s78, s76, 1152
    s_lshl_b32 s79, s77, 2
    s_add_u32 s78, s78, s79
    v_add_u32 v7, s78, v7
    v_lshlrev_b32 v5, 4, v5
    v_cmp_gt_u32 vcc, 16, v0
    v_mov_b32 v9, 2147483648
    s_nop 0
    v_cndmask_b32 v5, v9, v5, vcc
    s_lshl_b32 s78, s69, 16
    s_lshl_b32 s77, s77, 14
    s_add_u32 s78, s78, s77
    s_lshl_b32 s77, s83, 12
    s_add_u32 s78, s78, s77
    s_lshl_b32 s77, s88, 9
    s_add_u32 s78, s78, s77
    s_lshl_b32 s76, s76, 8
    s_add_u32 s78, s78, s76
    s_add_u32 s78, s78, 0x80000
    s_mov_b32 s3, 4
    s_waitcnt vmcnt(3)
    s_lshl_b32 s80, s68, 18
    s_add_u32 s80, s80, 32768
    s_add_u32 s81, s80, 8192
    buffer_load_dwordx4 v[80:83], v6, s[40:43], s80 offen nt
    buffer_load_dwordx4 v[84:87], v6, s[40:43], s81 offen nt
    s_lshl_b32 s80, s68, 18
    s_add_u32 s80, s80, 49152
    s_add_u32 s81, s80, 8192
    buffer_load_dwordx4 v[88:91], v6, s[40:43], s80 offen nt
    buffer_load_dwordx4 v[92:95], v6, s[40:43], s81 offen nt
    s_waitcnt vmcnt(4)
    s_waitcnt vmcnt(0)
    s_add_u32 s80, s59, 0
    buffer_load_dwordx4 v[96:99], v1, s[32:35], s80 offen nt
    buffer_load_dwordx4 v[100:103], v1, s[32:35], s80 offen offset:128 nt
    s_add_u32 s80, s59, 0
    buffer_load_dwordx4 v[104:107], v1, s[32:35], s80 offen offset:2048 nt
    buffer_load_dwordx4 v[108:111], v1, s[32:35], s80 offen offset:2176 nt
    s_waitcnt lgkmcnt(0)
    s_add_u32 s56, s56, 0x7f4a7c15
    s_addc_u32 s57, s57, 0x9e3779b9
    s_and_b32 s28, s56, 0xfff
    s_getreg_b32 s76, hwreg(HW_REG_XCC_ID)
    s_and_b32 s76, s76, 15
    s_andn2_b32 s86, s57, 15
    s_or_b32 s86, s86, s76
    v_perm_b32 v8, v68, v64, s72
    v_perm_b32 v9, v76, v72, s72
    v_perm_b32 v10, v84, v80, s72
    v_perm_b32 v11, v92, v88, s72
    v_perm_b32 v12, v68, v64, s73
    v_perm_b32 v13, v76, v72, s73
    v_perm_b32 v14, v84, v80, s73
    v_perm_b32 v15, v92, v88, s73
    v_mfma_f32_16x16x32_bf16 v[32:35], v[16:19], v[8:11], 0
    v_perm_b32 v8, v69, v65, s72
    v_perm_b32 v9, v77, v73, s72
    v_perm_b32 v10, v85, v81, s72
    v_perm_b32 v11, v93, v89, s72
    v_mfma_f32_16x16x32_bf16 v[36:39], v[16:19], v[12:15], 0
    v_perm_b32 v12, v69, v65, s73
    v_perm_b32 v13, v77, v73, s73
    v_perm_b32 v14, v85, v81, s73
    v_perm_b32 v15, v93, v89, s73
    v_mfma_f32_16x16x32_bf16 v[40:43], v[16:19], v[8:11], 0
    v_perm_b32 v8, v70, v66, s72
    v_perm_b32 v9, v78, v74, s72
    v_perm_b32 v10, v86, v82, s72
    v_perm_b32 v11, v94, v90, s72
    v_mfma_f32_16x16x32_bf16 v[44:47], v[16:19], v[12:15], 0
    v_perm_b32 v12, v70, v66, s73
    v_perm_b32 v13, v78, v74, s73
    v_perm_b32 v14, v86, v82, s73
    v_perm_b32 v15, v94, v90, s73
    v_mfma_f32_16x16x32_bf16 v[48:51], v[16:19], v[8:11], 0
    v_perm_b32 v8, v71, v67, s72
    v_perm_b32 v9, v79, v75, s72
    v_perm_b32 v10, v87, v83, s72
    v_perm_b32 v11, v95, v91, s72
    v_mfma_f32_16x16x32_bf16 v[52:55], v[16:19], v[12:15], 0
    v_perm_b32 v12, v71, v67, s73
    v_perm_b32 v13, v79, v75, s73
    v_perm_b32 v14, v87, v83, s73
    v_perm_b32 v15, v95, v91, s73
    v_mfma_f32_16x16x32_bf16 v[56:59], v[16:19], v[8:11], 0
    s_nop 0
    v_mfma_f32_16x16x32_bf16 v[60:63], v[16:19], v[12:15], 0
    s_mov_b64 exec, 0xffff
    ds_write_b128 v4, v[32:35]
    ds_write_b128 v4, v[36:39] offset:16
    ds_write_b128 v4, v[40:43] offset:32
    ds_write_b128 v4, v[44:47] offset:48
    ds_write_b128 v4, v[48:51] offset:64
    ds_write_b128 v4, v[52:55] offset:80
    ds_write_b128 v4, v[56:59] offset:96
    ds_write_b128 v4, v[60:63] offset:112
    s_mov_b64 exec, -1
    v_mov_b32 v6, s28
    s_waitcnt lgkmcnt(0)
    s_barrier
    v_add_u32 v4, 2304, v7
    ds_read2_b32 v[32:33], v7 offset0:0 offset1:4
    ds_read2_b32 v[34:35], v7 offset0:8 offset1:12
    ds_read2_b32 v[36:37], v4 offset0:0 offset1:4
    ds_read2_b32 v[38:39], v4 offset0:8 offset1:12
    s_waitcnt lgkmcnt(0)
    v_add_f32 v32, v32, v36
    v_add_f32 v33, v33, v37
    v_add_f32 v34, v34, v38
    v_add_f32 v35, v35, v39
    v_mov_b32 v36, v32
    v_mov_b32 v37, v33
    v_mov_b32 v38, v34
    v_mov_b32 v39, v35
    v_permlane16_swap_b32 v32, v36
    v_permlane16_swap_b32 v33, v37
    v_permlane16_swap_b32 v34, v38
    v_permlane16_swap_b32 v35, v39
    v_add_f32 v32, v32, v36
    v_add_f32 v33, v33, v37
    v_add_f32 v34, v34, v38
    v_add_f32 v35, v35, v39
    v_mov_b32 v36, v32
    v_mov_b32 v37, v33
    v_mov_b32 v38, v34
    v_mov_b32 v39, v35
    v_permlane32_swap_b32 v32, v36
    v_permlane32_swap_b32 v33, v37
    v_permlane32_swap_b32 v34, v38
    v_permlane32_swap_b32 v35, v39
    v_add_f32 v8, v32, v36
    v_add_f32 v9, v33, v37
    v_add_f32 v10, v34, v38
    v_add_f32 v11, v35, v39
    v_add_u32 v8, 2048, v8
    v_bfi_b32 v8, s29, v8, v6
    v_add_u32 v9, 2048, v9
    v_bfi_b32 v9, s29, v9, v6
    v_add_u32 v10, 2048, v10
    v_bfi_b32 v10, s29, v10, v6
    v_add_u32 v11, 2048, v11
    v_bfi_b32 v11, s29, v11, v6
    buffer_store_dwordx4 v[8:11], v5, s[52:55], s78 offen sc1
    s_mov_b32 s76, 0xffff0000
    v_lshlrev_b32 v12, 16, v28
    v_and_b32 v13, s76, v28
    v_lshlrev_b32 v14, 16, v24
    v_and_b32 v15, s76, v24
    v_mul_f32 v14, v14, v12
    v_mul_f32 v15, v15, v13
    v_cvt_pk_bf16_f32 v12, v14, v15
    v_lshlrev_b32 v14, 16, v12
    v_and_b32 v15, s76, v12
    v_add_f32 v4, v14, v15
    v_lshlrev_b32 v12, 16, v29
    v_and_b32 v13, s76, v29
    v_lshlrev_b32 v14, 16, v25
    v_and_b32 v15, s76, v25
    v_mul_f32 v14, v14, v12
    v_mul_f32 v15, v15, v13
    v_cvt_pk_bf16_f32 v12, v14, v15
    v_lshlrev_b32 v14, 16, v12
    v_and_b32 v15, s76, v12
    v_add_f32 v4, v4, v14
    v_add_f32 v4, v4, v15
    v_lshlrev_b32 v12, 16, v30
    v_and_b32 v13, s76, v30
    v_lshlrev_b32 v14, 16, v26
    v_and_b32 v15, s76, v26
    v_mul_f32 v14, v14, v12
    v_mul_f32 v15, v15, v13
    v_cvt_pk_bf16_f32 v12, v14, v15
    v_lshlrev_b32 v14, 16, v12
    v_and_b32 v15, s76, v12
    v_add_f32 v4, v4, v14
    v_add_f32 v4, v4, v15
    v_lshlrev_b32 v12, 16, v31
    v_and_b32 v13, s76, v31
    v_lshlrev_b32 v14, 16, v27
    v_and_b32 v15, s76, v27
    v_mul_f32 v14, v14, v12
    v_mul_f32 v15, v15, v13
    v_cvt_pk_bf16_f32 v12, v14, v15
    v_lshlrev_b32 v14, 16, v12
    v_and_b32 v15, s76, v12
    v_add_f32 v4, v4, v14
    v_add_f32 v4, v4, v15
    s_nop 1
    v_add_f32_dpp v5, v4, v4 row_ror:8 row_mask:0xf bank_mask:0xf
    v_mov_b32 v4, v5
    s_nop 1
    v_add_f32_dpp v5, v4, v4 row_ror:4 row_mask:0xf bank_mask:0xf
    v_mov_b32 v4, v5
    s_nop 1
    v_add_f32_dpp v5, v4, v4 row_ror:2 row_mask:0xf bank_mask:0xf
    v_mov_b32 v4, v5
    s_nop 1
    v_add_f32_dpp v5, v4, v4 row_ror:1 row_mask:0xf bank_mask:0xf
    v_mov_b32 v4, v5
    v_lshrrev_b32 v5, 4, v0
    v_lshlrev_b32 v5, 5, v5
    s_lshl_b32 s76, s68, 2
    v_add_u32 v5, s76, v5
    ds_write_b32 v5, v4 offset:36720
    v_and_b32 v4, 31, v0
    v_lshrrev_b32 v5, 5, v0
    v_lshlrev_b32 v7, 3, v4
    v_lshl_or_b32 v7, v5, 2, v7
    s_mul_i32 s76, s68, 272
    v_add_u32 v7, s76, v7
    v_lshlrev_b32 v14, 4, v4
    v_lshl_or_b32 v14, v5, 12, v14
    v_add_u32 v15, 4718592, v14
    v_mov_b32 v12, 0
    v_mov_b32 v13, 1
    s_waitcnt vmcnt(1)
    s_add_u32 s80, s59, 32768
    buffer_load_dwordx4 v[112:115], v1, s[32:35], s80 offen nt
    buffer_load_dwordx4 v[116:119], v1, s[32:35], s80 offen offset:128 nt
    s_add_u32 s80, s59, 32768
    buffer_load_dwordx4 v[120:123], v1, s[32:35], s80 offen offset:2048 nt
    buffer_load_dwordx4 v[124:127], v1, s[32:35], s80 offen offset:2176 nt
    s_waitcnt vmcnt(0)
    s_add_u32 s80, s59, 65536
    buffer_load_dwordx4 v[128:131], v1, s[32:35], s80 offen nt
    buffer_load_dwordx4 v[132:135], v1, s[32:35], s80 offen offset:128 nt
    s_add_u32 s80, s59, 65536
    buffer_load_dwordx4 v[136:139], v1, s[32:35], s80 offen offset:2048 nt
    buffer_load_dwordx4 v[140:143], v1, s[32:35], s80 offen offset:2176 nt
    s_waitcnt vmcnt(0)
    s_add_u32 s80, s59, 98304
    buffer_load_dwordx4 v[144:147], v1, s[32:35], s80 offen nt
    buffer_load_dwordx4 v[148:151], v1, s[32:35], s80 offen offset:128 nt
    s_add_u32 s80, s59, 98304
    buffer_load_dwordx4 v[152:155], v1, s[32:35], s80 offen offset:2048 nt
    buffer_load_dwordx4 v[156:159], v1, s[32:35], s80 offen offset:2176 nt
    s_waitcnt vmcnt(0)
    s_add_u32 s80, s59, 131072
    buffer_load_dwordx4 v[160:163], v1, s[32:35], s80 offen nt
    buffer_load_dwordx4 v[164:167], v1, s[32:35], s80 offen offset:128 nt
    s_add_u32 s80, s59, 131072
    buffer_load_dwordx4 v[168:171], v1, s[32:35], s80 offen offset:2048 nt
    buffer_load_dwordx4 v[172:175], v1, s[32:35], s80 offen offset:2176 nt
    s_waitcnt vmcnt(0)
    s_add_u32 s80, s59, 163840
    buffer_load_dwordx4 v[176:179], v1, s[32:35], s80 offen nt
    buffer_load_dwordx4 v[180:183], v1, s[32:35], s80 offen offset:128 nt
    s_add_u32 s80, s59, 163840
    buffer_load_dwordx4 v[184:187], v1, s[32:35], s80 offen offset:2048 nt
    buffer_load_dwordx4 v[188:191], v1, s[32:35], s80 offen offset:2176 nt
    s_waitcnt vmcnt(0)
    s_add_u32 s80, s59, 196608
    buffer_load_dwordx4 v[192:195], v1, s[32:35], s80 offen nt
    buffer_load_dwordx4 v[196:199], v1, s[32:35], s80 offen offset:128 nt
    s_add_u32 s80, s59, 196608
    buffer_load_dwordx4 v[200:203], v1, s[32:35], s80 offen offset:2048 nt
    buffer_load_dwordx4 v[204:207], v1, s[32:35], s80 offen offset:2176 nt
    s_waitcnt vmcnt(0)
    buffer_load_dwordx4 v[24:27], v14, s[52:55], s58 offen sc1
    buffer_load_dwordx4 v[28:31], v14, s[52:55], s75 offen sc1
    s_add_u32 s80, s59, 229376
    buffer_load_dwordx4 v[208:211], v1, s[32:35], s80 offen nt
    buffer_load_dwordx4 v[212:215], v1, s[32:35], s80 offen offset:128 nt
    s_add_u32 s80, s59, 229376
    buffer_load_dwordx4 v[216:219], v1, s[32:35], s80 offen offset:2048 nt
    buffer_load_dwordx4 v[220:223], v1, s[32:35], s80 offen offset:2176 nt
    s_waitcnt vmcnt(0)
    s_cmp_lg_u32 s71, 0
    s_cbranch_scc1 L_qhave
    s_mov_b32 s82, 0x10000
    s_waitcnt vmcnt(0)
L_spin0:
    v_xor_b32 v24, s28, v24
    v_xor_b32 v25, s28, v25
    v_xor_b32 v26, s28, v26
    v_xor_b32 v27, s28, v27
    v_xor_b32 v28, s28, v28
    v_xor_b32 v29, s28, v29
    v_xor_b32 v30, s28, v30
    v_xor_b32 v31, s28, v31
    v_or3_b32 v4, v24, v25, v26
    v_or3_b32 v4, v4, v27, v28
    v_or3_b32 v4, v4, v29, v30
    v_or_b32 v4, v4, v31
    v_and_b32 v4, 4095, v4
    v_cmp_ne_u32 vcc, 0, v4
    s_cbranch_vccz L_q_ok
    s_sleep 8
    buffer_load_dwordx4 v[24:27], v14, s[52:55], s58 offen sc1
    buffer_load_dwordx4 v[28:31], v14, s[52:55], s75 offen sc1
    s_waitcnt vmcnt(0)
    s_sub_u32 s82, s82, 1
    s_cmp_lg_u32 s82, 0
    s_cbranch_scc1 L_spin0
L_q_ok:
    v_add_f32 v24, v24, v28
    v_add_f32 v25, v25, v29
    v_add_f32 v26, v26, v30
    v_add_f32 v27, v27, v31
    s_nop 0
    v_permlane32_swap_b32 v24, v26
    v_permlane32_swap_b32 v25, v27
    v_add_f32 v24, v24, v26
    v_add_f32 v25, v25, v27
    v_cvt_pk_bf16_f32 v24, v24, v25
    ds_write_b32 v7, v24 offset:32768
    s_mov_b64 exec, 1
    ds_add_u32 v12, v13 offset:34960
    s_mov_b64 exec, -1
    s_mov_b32 s71, 1
L_qhave:
    s_add_u32 s80, s59, 0
    buffer_load_dwordx4 v[224:227], v2, s[36:39], s80 offen nt
    buffer_load_dwordx4 v[228:231], v2, s[36:39], s80 offen offset:1024 nt
    s_add_u32 s80, s59, 0
    buffer_load_dwordx4 v[232:235], v2, s[36:39], s80 offen offset:2048 nt
    buffer_load_dwordx4 v[236:239], v2, s[36:39], s80 offen offset:3072 nt
    v_and_b32 v6, 7, v0
    v_mul_u32_u24 v6, 272, v6
    v_lshrrev_b32 v7, 3, v0
    v_lshl_add_u32 v6, v7, 4, v6
    v_mov_b32 v5, 0
    s_mov_b32 s82, 0x100000
L_wq:
    ds_read_b32 v4, v5 offset:34960
    s_waitcnt lgkmcnt(0)
    v_readfirstlane_b32 s76, v4
    s_cmp_ge_u32 s76, 8
    s_cbranch_scc1 L_wq_ok
    s_sleep 1
    s_sub_u32 s82, s82, 1
    s_cmp_lg_u32 s82, 0
    s_cbranch_scc1 L_wq
L_wq_ok:
    ds_read_b128 v[8:11], v6 offset:32768
    ds_read_b128 v[12:15], v6 offset:32896
    s_waitcnt lgkmcnt(0)
    v_mfma_f32_16x16x32_bf16 v[32:35], v[96:99], v[8:11], 0
    v_mfma_f32_16x16x32_bf16 v[36:39], v[104:107], v[8:11], 0
    v_mfma_f32_16x16x32_bf16 v[40:43], v[112:115], v[8:11], 0
    v_mfma_f32_16x16x32_bf16 v[44:47], v[120:123], v[8:11], 0
    v_mfma_f32_16x16x32_bf16 v[32:35], v[100:103], v[12:15], v[32:35]
    v_mfma_f32_16x16x32_bf16 v[36:39], v[108:111], v[12:15], v[36:39]
    v_mfma_f32_16x16x32_bf16 v[40:43], v[116:119], v[12:15], v[40:43]
    v_mfma_f32_16x16x32_bf16 v[44:47], v[124:127], v[12:15], v[44:47]
    v_mfma_f32_16x16x32_bf16 v[48:51], v[128:131], v[8:11], 0
    v_mfma_f32_16x16x32_bf16 v[52:55], v[136:139], v[8:11], 0
    v_mfma_f32_16x16x32_bf16 v[56:59], v[144:147], v[8:11], 0
    v_mfma_f32_16x16x32_bf16 v[60:63], v[152:155], v[8:11], 0
    v_mfma_f32_16x16x32_bf16 v[48:51], v[132:135], v[12:15], v[48:51]
    v_mfma_f32_16x16x32_bf16 v[52:55], v[140:143], v[12:15], v[52:55]
    v_mfma_f32_16x16x32_bf16 v[56:59], v[148:151], v[12:15], v[56:59]
    v_mfma_f32_16x16x32_bf16 v[60:63], v[156:159], v[12:15], v[60:63]
    v_add_f32_dpp v16, v33, v32 row_ror:8 row_mask:0xf bank_mask:0x3
    v_add_f32_dpp v16, v34, v35 row_ror:8 row_mask:0xf bank_mask:0xc
    v_add_f32_dpp v17, v37, v36 row_ror:8 row_mask:0xf bank_mask:0x3
    v_add_f32_dpp v17, v38, v39 row_ror:8 row_mask:0xf bank_mask:0xc
    v_add_f32_dpp v18, v41, v40 row_ror:8 row_mask:0xf bank_mask:0x3
    v_add_f32_dpp v18, v42, v43 row_ror:8 row_mask:0xf bank_mask:0xc
    v_add_f32_dpp v19, v45, v44 row_ror:8 row_mask:0xf bank_mask:0x3
    v_add_f32_dpp v19, v46, v47 row_ror:8 row_mask:0xf bank_mask:0xc
    v_mfma_f32_16x16x32_bf16 v[32:35], v[160:163], v[8:11], 0
    v_mfma_f32_16x16x32_bf16 v[36:39], v[168:171], v[8:11], 0
    v_mfma_f32_16x16x32_bf16 v[40:43], v[176:179], v[8:11], 0
    v_mfma_f32_16x16x32_bf16 v[44:47], v[184:187], v[8:11], 0
    v_mfma_f32_16x16x32_bf16 v[32:35], v[164:167], v[12:15], v[32:35]
    v_mfma_f32_16x16x32_bf16 v[36:39], v[172:175], v[12:15], v[36:39]
    v_mfma_f32_16x16x32_bf16 v[40:43], v[180:183], v[12:15], v[40:43]
    v_mfma_f32_16x16x32_bf16 v[44:47], v[188:191], v[12:15], v[44:47]
    v_add_f32_dpp v20, v49, v48 row_ror:8 row_mask:0xf bank_mask:0x3
    v_add_f32_dpp v20, v50, v51 row_ror:8 row_mask:0xf bank_mask:0xc
    v_add_f32_dpp v21, v53, v52 row_ror:8 row_mask:0xf bank_mask:0x3
    v_add_f32_dpp v21, v54, v55 row_ror:8 row_mask:0xf bank_mask:0xc
    v_add_f32_dpp v22, v57, v56 row_ror:8 row_mask:0xf bank_mask:0x3
    v_add_f32_dpp v22, v58, v59 row_ror:8 row_mask:0xf bank_mask:0xc
    v_add_f32_dpp v23, v61, v60 row_ror:8 row_mask:0xf bank_mask:0x3
    v_add_f32_dpp v23, v62, v63 row_ror:8 row_mask:0xf bank_mask:0xc
    v_mfma_f32_16x16x32_bf16 v[48:51], v[192:195], v[8:11], 0
    v_mfma_f32_16x16x32_bf16 v[52:55], v[200:203], v[8:11], 0
    v_mfma_f32_16x16x32_bf16 v[56:59], v[208:211], v[8:11], 0
    v_mfma_f32_16x16x32_bf16 v[60:63], v[216:219], v[8:11], 0
    v_mfma_f32_16x16x32_bf16 v[48:51], v[196:199], v[12:15], v[48:51]
    v_mfma_f32_16x16x32_bf16 v[52:55], v[204:207], v[12:15], v[52:55]
    v_mfma_f32_16x16x32_bf16 v[56:59], v[212:215], v[12:15], v[56:59]
    v_mfma_f32_16x16x32_bf16 v[60:63], v[220:223], v[12:15], v[60:63]
    v_add_f32_dpp v24, v33, v32 row_ror:8 row_mask:0xf bank_mask:0x3
    v_add_f32_dpp v24, v34, v35 row_ror:8 row_mask:0xf bank_mask:0xc
    v_add_f32_dpp v25, v37, v36 row_ror:8 row_mask:0xf bank_mask:0x3
    v_add_f32_dpp v25, v38, v39 row_ror:8 row_mask:0xf bank_mask:0xc
    v_add_f32_dpp v26, v41, v40 row_ror:8 row_mask:0xf bank_mask:0x3
    v_add_f32_dpp v26, v42, v43 row_ror:8 row_mask:0xf bank_mask:0xc
    v_add_f32_dpp v27, v45, v44 row_ror:8 row_mask:0xf bank_mask:0x3
    v_add_f32_dpp v27, v46, v47 row_ror:8 row_mask:0xf bank_mask:0xc
    v_add_f32_dpp v28, v49, v48 row_ror:8 row_mask:0xf bank_mask:0x3
    v_add_f32_dpp v28, v50, v51 row_ror:8 row_mask:0xf bank_mask:0xc
    v_add_f32_dpp v29, v53, v52 row_ror:8 row_mask:0xf bank_mask:0x3
    v_add_f32_dpp v29, v54, v55 row_ror:8 row_mask:0xf bank_mask:0xc
    v_add_f32_dpp v30, v57, v56 row_ror:8 row_mask:0xf bank_mask:0x3
    v_add_f32_dpp v30, v58, v59 row_ror:8 row_mask:0xf bank_mask:0xc
    v_add_f32_dpp v31, v61, v60 row_ror:8 row_mask:0xf bank_mask:0x3
    v_add_f32_dpp v31, v62, v63 row_ror:8 row_mask:0xf bank_mask:0xc
    v_lshrrev_b32 v1, 4, v0
    v_lshlrev_b32 v1, 14, v1
    v_and_b32 v5, 15, v0
    v_lshl_or_b32 v1, v5, 4, v1
    v_cvt_pk_bf16_f32 v16, v16, v16
    v_and_b32 v16, 4294901760, v16
    v_mul_f32 v16, s93, v16
    v_cvt_pk_bf16_f32 v16, v16, v16
    v_and_b32 v16, 4294901760, v16
    v_cvt_pk_bf16_f32 v17, v17, v17
    v_and_b32 v17, 4294901760, v17
    v_mul_f32 v17, s93, v17
    v_cvt_pk_bf16_f32 v17, v17, v17
    v_and_b32 v17, 4294901760, v17
    v_cvt_pk_bf16_f32 v18, v18, v18
    v_and_b32 v18, 4294901760, v18
    v_mul_f32 v18, s93, v18
    v_cvt_pk_bf16_f32 v18, v18, v18
    v_and_b32 v18, 4294901760, v18
    v_cvt_pk_bf16_f32 v19, v19, v19
    v_and_b32 v19, 4294901760, v19
    v_mul_f32 v19, s93, v19
    v_cvt_pk_bf16_f32 v19, v19, v19
    v_and_b32 v19, 4294901760, v19
    v_cvt_pk_bf16_f32 v20, v20, v20
    v_and_b32 v20, 4294901760, v20
    v_mul_f32 v20, s93, v20
    v_cvt_pk_bf16_f32 v20, v20, v20
    v_and_b32 v20, 4294901760, v20
    v_cvt_pk_bf16_f32 v21, v21, v21
    v_and_b32 v21, 4294901760, v21
    v_mul_f32 v21, s93, v21
    v_cvt_pk_bf16_f32 v21, v21, v21
    v_and_b32 v21, 4294901760, v21
    v_cvt_pk_bf16_f32 v22, v22, v22
    v_and_b32 v22, 4294901760, v22
    v_mul_f32 v22, s93, v22
    v_cvt_pk_bf16_f32 v22, v22, v22
    v_and_b32 v22, 4294901760, v22
    v_cvt_pk_bf16_f32 v23, v23, v23
    v_and_b32 v23, 4294901760, v23
    v_mul_f32 v23, s93, v23
    v_cvt_pk_bf16_f32 v23, v23, v23
    v_and_b32 v23, 4294901760, v23
    v_cvt_pk_bf16_f32 v24, v24, v24
    v_and_b32 v24, 4294901760, v24
    v_mul_f32 v24, s93, v24
    v_cvt_pk_bf16_f32 v24, v24, v24
    v_and_b32 v24, 4294901760, v24
    v_cvt_pk_bf16_f32 v25, v25, v25
    v_and_b32 v25, 4294901760, v25
    v_mul_f32 v25, s93, v25
    v_cvt_pk_bf16_f32 v25, v25, v25
    v_and_b32 v25, 4294901760, v25
    v_cvt_pk_bf16_f32 v26, v26, v26
    v_and_b32 v26, 4294901760, v26
    v_mul_f32 v26, s93, v26
    v_cvt_pk_bf16_f32 v26, v26, v26
    v_and_b32 v26, 4294901760, v26
    v_cvt_pk_bf16_f32 v27, v27, v27
    v_and_b32 v27, 4294901760, v27
    v_mul_f32 v27, s93, v27
    v_cvt_pk_bf16_f32 v27, v27, v27
    v_and_b32 v27, 4294901760, v27
    v_cvt_pk_bf16_f32 v28, v28, v28
    v_and_b32 v28, 4294901760, v28
    v_mul_f32 v28, s93, v28
    v_cvt_pk_bf16_f32 v28, v28, v28
    v_and_b32 v28, 4294901760, v28
    v_cvt_pk_bf16_f32 v29, v29, v29
    v_and_b32 v29, 4294901760, v29
    v_mul_f32 v29, s93, v29
    v_cvt_pk_bf16_f32 v29, v29, v29
    v_and_b32 v29, 4294901760, v29
    v_cvt_pk_bf16_f32 v30, v30, v30
    v_and_b32 v30, 4294901760, v30
    v_mul_f32 v30, s93, v30
    v_cvt_pk_bf16_f32 v30, v30, v30
    v_and_b32 v30, 4294901760, v30
    v_cvt_pk_bf16_f32 v31, v31, v31
    v_and_b32 v31, 4294901760, v31
    v_mul_f32 v31, s93, v31
    v_cvt_pk_bf16_f32 v31, v31, v31
    v_and_b32 v31, 4294901760, v31
    s_waitcnt vmcnt(0)
    s_add_u32 s80, s59, 32768
    buffer_load_dwordx4 v[240:243], v2, s[36:39], s80 offen nt
    buffer_load_dwordx4 v[244:247], v2, s[36:39], s80 offen offset:1024 nt
    s_add_u32 s80, s59, 32768
    buffer_load_dwordx4 v[248:251], v2, s[36:39], s80 offen offset:2048 nt
    buffer_load_dwordx4 v[252:255], v2, s[36:39], s80 offen offset:3072 nt
    v_max3_f32 v4, v16, v17, v18
    v_max3_f32 v4, v4, v19, v20
    v_max3_f32 v4, v4, v21, v22
    v_max3_f32 v4, v4, v23, v24
    v_max3_f32 v4, v4, v25, v26
    v_max3_f32 v4, v4, v27, v28
    v_max3_f32 v4, v4, v29, v30
    v_max_f32 v4, v4, v31
    s_nop 1
    v_max_f32_dpp v5, v4, v4 row_ror:8 row_mask:0xf bank_mask:0xf
    v_mov_b32 v4, v5
    s_nop 1
    v_permlane16_swap_b32 v4, v5
    v_max_f32 v4, v4, v5
    v_mov_b32 v5, v4
    s_nop 1
    v_permlane32_swap_b32 v4, v5
    v_max_f32 v4, v4, v5
    v_mul_f32 v4, s94, v4
    v_and_b32 v6, 7, v0
    v_lshlrev_b32 v6, 5, v6
    s_lshl_b32 s76, s68, 2
    v_add_u32 v7, s76, v6
    ds_write_b32 v7, v4 offset:35072
    v_fma_f32 v16, v16, s94, -v4
    v_fma_f32 v17, v17, s94, -v4
    v_fma_f32 v18, v18, s94, -v4
    v_fma_f32 v19, v19, s94, -v4
    v_fma_f32 v20, v20, s94, -v4
    v_fma_f32 v21, v21, s94, -v4
    v_fma_f32 v22, v22, s94, -v4
    v_fma_f32 v23, v23, s94, -v4
    v_fma_f32 v24, v24, s94, -v4
    v_fma_f32 v25, v25, s94, -v4
    v_fma_f32 v26, v26, s94, -v4
    v_fma_f32 v27, v27, s94, -v4
    v_fma_f32 v28, v28, s94, -v4
    v_fma_f32 v29, v29, s94, -v4
    v_fma_f32 v30, v30, s94, -v4
    v_fma_f32 v31, v31, s94, -v4
    v_exp_f32 v16, v16
    v_exp_f32 v17, v17
    v_exp_f32 v18, v18
    v_exp_f32 v19, v19
    v_exp_f32 v20, v20
    v_exp_f32 v21, v21
    v_exp_f32 v22, v22
    v_exp_f32 v23, v23
    v_exp_f32 v24, v24
    v_exp_f32 v25, v25
    v_exp_f32 v26, v26
    v_exp_f32 v27, v27
    v_exp_f32 v28, v28
    v_exp_f32 v29, v29
    v_exp_f32 v30, v30
    v_exp_f32 v31, v31
    v_add_f32 v5, v16, v17
    v_add_f32 v5, v5, v18
    v_add_f32 v5, v5, v19
    v_add_f32 v5, v5, v20
    v_add_f32 v5, v5, v21
    v_add_f32 v5, v5, v22
    v_add_f32 v5, v5, v23
    v_add_f32 v5, v5, v24
    v_add_f32 v5, v5, v25
    v_add_f32 v5, v5, v26
    v_add_f32 v5, v5, v27
    v_add_f32 v5, v5, v28
    v_add_f32 v5, v5, v29
    v_add_f32 v5, v5, v30
    v_add_f32 v5, v5, v31
    v_cvt_pk_bf16_f32 v16, v16, v16
    v_and_b32 v16, v3, v16
    v_cvt_pk_bf16_f32 v17, v17, v17
    v_and_b32 v17, v3, v17
    v_cvt_pk_bf16_f32 v18, v18, v18
    v_and_b32 v18, v3, v18
    v_cvt_pk_bf16_f32 v19, v19, v19
    v_and_b32 v19, v3, v19
    v_cvt_pk_bf16_f32 v20, v20, v20
    v_and_b32 v20, v3, v20
    v_cvt_pk_bf16_f32 v21, v21, v21
    v_and_b32 v21, v3, v21
    v_cvt_pk_bf16_f32 v22, v22, v22
    v_and_b32 v22, v3, v22
    v_cvt_pk_bf16_f32 v23, v23, v23
    v_and_b32 v23, v3, v23
    v_cvt_pk_bf16_f32 v24, v24, v24
    v_and_b32 v24, v3, v24
    v_cvt_pk_bf16_f32 v25, v25, v25
    v_and_b32 v25, v3, v25
    v_cvt_pk_bf16_f32 v26, v26, v26
    v_and_b32 v26, v3, v26
    v_cvt_pk_bf16_f32 v27, v27, v27
    v_and_b32 v27, v3, v27
    v_cvt_pk_bf16_f32 v28, v28, v28
    v_and_b32 v28, v3, v28
    v_cvt_pk_bf16_f32 v29, v29, v29
    v_and_b32 v29, v3, v29
    v_cvt_pk_bf16_f32 v30, v30, v30
    v_and_b32 v30, v3, v30
    v_cvt_pk_bf16_f32 v31, v31, v31
    v_and_b32 v31, v3, v31
    v_add_f32_dpp v32, v5, v5 row_ror:8 row_mask:0xf bank_mask:0xf
    v_mov_b32 v5, v32
    s_nop 1
    v_permlane16_swap_b32 v5, v32
    v_add_f32 v5, v5, v32
    v_mov_b32 v32, v5
    s_nop 1
    v_permlane32_swap_b32 v5, v32
    v_add_f32 v5, v5, v32
    ds_write_b32 v7, v5 offset:35328
    v_mov_b32 v192, 0
    v_mov_b32 v193, 1
    s_mov_b64 exec, 1
    ds_add_rtn_u32 v194, v192, v193 offset:34964
    s_mov_b64 exec, -1
    s_waitcnt lgkmcnt(0)
    v_readfirstlane_b32 s76, v194
    s_cmp_lg_u32 s76, 7
    s_cbranch_scc1 L_noml
    ds_read_b128 v[192:195], v6 offset:35072
    ds_read_b128 v[196:199], v6 offset:35088
    ds_read_b128 v[200:203], v6 offset:35328
    ds_read_b128 v[204:207], v6 offset:35344
    v_cmp_gt_u32 vcc, 8, v0
    v_mov_b32 v209, 2147483648
    s_nop 0
    v_cndmask_b32 v208, v209, v2, vcc
    v_mov_b32 v213, s56
    v_mov_b32 v215, s86
    s_waitcnt lgkmcnt(0)
    v_max3_f32 v4, v192, v193, v194
    v_max3_f32 v4, v4, v195, v196
    v_max3_f32 v4, v4, v197, v198
    v_max_f32 v4, v4, v199
    v_sub_f32 v192, v192, v4
    v_sub_f32 v193, v193, v4
    v_sub_f32 v194, v194, v4
    v_sub_f32 v195, v195, v4
    v_sub_f32 v196, v196, v4
    v_sub_f32 v197, v197, v4
    v_sub_f32 v198, v198, v4
    v_sub_f32 v199, v199, v4
    v_exp_f32 v192, v192
    v_exp_f32 v193, v193
    v_exp_f32 v194, v194
    v_exp_f32 v195, v195
    v_exp_f32 v196, v196
    v_exp_f32 v197, v197
    v_exp_f32 v198, v198
    v_exp_f32 v199, v199
    v_mul_f32 v5, v192, v200
    v_fma_f32 v5, v193, v201, v5
    v_fma_f32 v5, v194, v202, v5
    v_fma_f32 v5, v195, v203, v5
    v_fma_f32 v5, v196, v204, v5
    v_fma_f32 v5, v197, v205, v5
    v_fma_f32 v5, v198, v206, v5
    v_fma_f32 v5, v199, v207, v5
    v_mov_b32 v212, v4
    v_mov_b32 v214, v5
    s_lshl_b32 s76, s92, 7
    s_add_u32 s76, s76, 0x200000
    buffer_store_dwordx4 v[212:215], v208, s[52:55], s76 offen sc1
L_noml:
    v_mov_b32 v3, s28
    s_waitcnt vmcnt(0)
    s_add_u32 s80, s59, 65536
    buffer_load_dwordx4 v[64:67], v2, s[36:39], s80 offen nt
    buffer_load_dwordx4 v[68:71], v2, s[36:39], s80 offen offset:1024 nt
    s_add_u32 s80, s59, 65536
    buffer_load_dwordx4 v[72:75], v2, s[36:39], s80 offen offset:2048 nt
    buffer_load_dwordx4 v[76:79], v2, s[36:39], s80 offen offset:3072 nt
    v_perm_b32 v8, v228, v224, s72
    v_perm_b32 v9, v236, v232, s72
    v_perm_b32 v10, v244, v240, s72
    v_perm_b32 v11, v252, v248, s72
    v_perm_b32 v12, v228, v224, s73
    v_perm_b32 v13, v236, v232, s73
    v_perm_b32 v14, v244, v240, s73
    v_perm_b32 v15, v252, v248, s73
    v_mfma_f32_16x16x32_bf16 v[32:35], v[16:19], v[8:11], 0
    v_perm_b32 v8, v229, v225, s72
    v_perm_b32 v9, v237, v233, s72
    v_perm_b32 v10, v245, v241, s72
    v_perm_b32 v11, v253, v249, s72
    v_mfma_f32_16x16x32_bf16 v[36:39], v[16:19], v[12:15], 0
    v_perm_b32 v12, v229, v225, s73
    v_perm_b32 v13, v237, v233, s73
    v_perm_b32 v14, v245, v241, s73
    v_perm_b32 v15, v253, v249, s73
    v_mfma_f32_16x16x32_bf16 v[40:43], v[16:19], v[8:11], 0
    v_perm_b32 v8, v230, v226, s72
    v_perm_b32 v9, v238, v234, s72
    v_perm_b32 v10, v246, v242, s72
    v_perm_b32 v11, v254, v250, s72
    v_mfma_f32_16x16x32_bf16 v[44:47], v[16:19], v[12:15], 0
    v_perm_b32 v12, v230, v226, s73
    v_perm_b32 v13, v238, v234, s73
    v_perm_b32 v14, v246, v242, s73
    v_perm_b32 v15, v254, v250, s73
    v_mfma_f32_16x16x32_bf16 v[48:51], v[16:19], v[8:11], 0
    v_perm_b32 v8, v231, v227, s72
    v_perm_b32 v9, v239, v235, s72
    v_perm_b32 v10, v247, v243, s72
    v_perm_b32 v11, v255, v251, s72
    v_mfma_f32_16x16x32_bf16 v[52:55], v[16:19], v[12:15], 0
    v_perm_b32 v12, v231, v227, s73
    v_perm_b32 v13, v239, v235, s73
    v_perm_b32 v14, v247, v243, s73
    v_perm_b32 v15, v255, v251, s73
    v_mfma_f32_16x16x32_bf16 v[56:59], v[16:19], v[8:11], 0
    s_nop 0
    v_mfma_f32_16x16x32_bf16 v[60:63], v[16:19], v[12:15], 0
    s_waitcnt vmcnt(0)
    s_lshl_b32 s76, s2, 12
    s_add_u32 s76, s76, 0x300000
    s_lshl_b32 s77, s90, 10
    s_add_u32 s76, s76, s77
    s_cmp_lt_u32 s68, 4
    s_cselect_b32 s76, 0x80000000, s76
    buffer_load_dwordx4 v[220:223], v2, s[52:55], s76 offen sc1
    s_cmp_lg_u32 s68, 7
    s_cbranch_scc1 L_notlb2
    v_mov_b32 v218, 0
    s_lshl_b32 s77, s2, 3
    buffer_load_dword v219, v218, s[60:63], s77 offen
    buffer_load_dword v217, v218, s[44:47], 0 offen nt
L_notlb2:
    s_add_u32 s80, s59, 98304
    buffer_load_dwordx4 v[80:83], v2, s[36:39], s80 offen nt
    buffer_load_dwordx4 v[84:87], v2, s[36:39], s80 offen offset:1024 nt
    s_add_u32 s80, s59, 98304
    buffer_load_dwordx4 v[88:91], v2, s[36:39], s80 offen offset:2048 nt
    buffer_load_dwordx4 v[92:95], v2, s[36:39], s80 offen offset:3072 nt
    s_waitcnt vmcnt(0)
    s_add_u32 s80, s59, 131072
    buffer_load_dwordx4 v[96:99], v2, s[36:39], s80 offen nt
    buffer_load_dwordx4 v[100:103], v2, s[36:39], s80 offen offset:1024 nt
    s_add_u32 s80, s59, 131072
    buffer_load_dwordx4 v[104:107], v2, s[36:39], s80 offen offset:2048 nt
    buffer_load_dwordx4 v[108:111], v2, s[36:39], s80 offen offset:3072 nt
    v_perm_b32 v8, v68, v64, s72
    v_perm_b32 v9, v76, v72, s72
    v_perm_b32 v10, v84, v80, s72
    v_perm_b32 v11, v92, v88, s72
    v_perm_b32 v12, v68, v64, s73
    v_perm_b32 v13, v76, v72, s73
    v_perm_b32 v14, v84, v80, s73
    v_perm_b32 v15, v92, v88, s73
    v_mfma_f32_16x16x32_bf16 v[32:35], v[20:23], v[8:11], v[32:35]
    v_perm_b32 v8, v69, v65, s72
    v_perm_b32 v9, v77, v73, s72
    v_perm_b32 v10, v85, v81, s72
    v_perm_b32 v11, v93, v89, s72
    v_mfma_f32_16x16x32_bf16 v[36:39], v[20:23], v[12:15], v[36:39]
    v_perm_b32 v12, v69, v65, s73
    v_perm_b32 v13, v77, v73, s73
    v_perm_b32 v14, v85, v81, s73
    v_perm_b32 v15, v93, v89, s73
    v_mfma_f32_16x16x32_bf16 v[40:43], v[20:23], v[8:11], v[40:43]
    v_perm_b32 v8, v70, v66, s72
    v_perm_b32 v9, v78, v74, s72
    v_perm_b32 v10, v86, v82, s72
    v_perm_b32 v11, v94, v90, s72
    v_mfma_f32_16x16x32_bf16 v[44:47], v[20:23], v[12:15], v[44:47]
    v_perm_b32 v12, v70, v66, s73
    v_perm_b32 v13, v78, v74, s73
    v_perm_b32 v14, v86, v82, s73
    v_perm_b32 v15, v94, v90, s73
    v_mfma_f32_16x16x32_bf16 v[48:51], v[20:23], v[8:11], v[48:51]
    v_perm_b32 v8, v71, v67, s72
    v_perm_b32 v9, v79, v75, s72
    v_perm_b32 v10, v87, v83, s72
    v_perm_b32 v11, v95, v91, s72
    v_mfma_f32_16x16x32_bf16 v[52:55], v[20:23], v[12:15], v[52:55]
    v_perm_b32 v12, v71, v67, s73
    v_perm_b32 v13, v79, v75, s73
    v_perm_b32 v14, v87, v83, s73
    v_perm_b32 v15, v95, v91, s73
    v_mfma_f32_16x16x32_bf16 v[56:59], v[20:23], v[8:11], v[56:59]
    s_nop 0
    v_mfma_f32_16x16x32_bf16 v[60:63], v[20:23], v[12:15], v[60:63]
    s_waitcnt vmcnt(0)
    s_cmp_lt_u32 s68, 4
    s_cbranch_scc1 L_nomlg
    v_lshrrev_b32 v216, 3, v0
    v_lshlrev_b32 v216, 7, v216
    buffer_load_dwordx4 v[192:195], v216, s[52:55], s95 offen sc1
    buffer_load_dwordx4 v[196:199], v216, s[52:55], s95 offen offset:1024 sc1
    buffer_load_dwordx4 v[200:203], v216, s[52:55], s95 offen offset:2048 sc1
    buffer_load_dwordx4 v[204:207], v216, s[52:55], s95 offen offset:3072 sc1
L_nomlg:
    s_add_u32 s80, s59, 163840
    buffer_load_dwordx4 v[112:115], v2, s[36:39], s80 offen nt
    buffer_load_dwordx4 v[116:119], v2, s[36:39], s80 offen offset:1024 nt
    s_add_u32 s80, s59, 163840
    buffer_load_dwordx4 v[120:123], v2, s[36:39], s80 offen offset:2048 nt
    buffer_load_dwordx4 v[124:127], v2, s[36:39], s80 offen offset:3072 nt
    s_waitcnt vmcnt(0)
    s_add_u32 s80, s59, 196608
    buffer_load_dwordx4 v[128:131], v2, s[36:39], s80 offen nt
    buffer_load_dwordx4 v[132:135], v2, s[36:39], s80 offen offset:1024 nt
    s_add_u32 s80, s59, 196608
    buffer_load_dwordx4 v[136:139], v2, s[36:39], s80 offen offset:2048 nt
    buffer_load_dwordx4 v[140:143], v2, s[36:39], s80 offen offset:3072 nt
    v_perm_b32 v8, v100, v96, s72
    v_perm_b32 v9, v108, v104, s72
    v_perm_b32 v10, v116, v112, s72
    v_perm_b32 v11, v124, v120, s72
    v_perm_b32 v12, v100, v96, s73
    v_perm_b32 v13, v108, v104, s73
    v_perm_b32 v14, v116, v112, s73
    v_perm_b32 v15, v124, v120, s73
    v_mfma_f32_16x16x32_bf16 v[32:35], v[24:27], v[8:11], v[32:35]
    v_perm_b32 v8, v101, v97, s72
    v_perm_b32 v9, v109, v105, s72
    v_perm_b32 v10, v117, v113, s72
    v_perm_b32 v11, v125, v121, s72
    v_mfma_f32_16x16x32_bf16 v[36:39], v[24:27], v[12:15], v[36:39]
    v_perm_b32 v12, v101, v97, s73
    v_perm_b32 v13, v109, v105, s73
    v_perm_b32 v14, v117, v113, s73
    v_perm_b32 v15, v125, v121, s73
    v_mfma_f32_16x16x32_bf16 v[40:43], v[24:27], v[8:11], v[40:43]
    v_perm_b32 v8, v102, v98, s72
    v_perm_b32 v9, v110, v106, s72
    v_perm_b32 v10, v118, v114, s72
    v_perm_b32 v11, v126, v122, s72
    v_mfma_f32_16x16x32_bf16 v[44:47], v[24:27], v[12:15], v[44:47]
    v_perm_b32 v12, v102, v98, s73
    v_perm_b32 v13, v110, v106, s73
    v_perm_b32 v14, v118, v114, s73
    v_perm_b32 v15, v126, v122, s73
    v_mfma_f32_16x16x32_bf16 v[48:51], v[24:27], v[8:11], v[48:51]
    v_perm_b32 v8, v103, v99, s72
    v_perm_b32 v9, v111, v107, s72
    v_perm_b32 v10, v119, v115, s72
    v_perm_b32 v11, v127, v123, s72
    v_mfma_f32_16x16x32_bf16 v[52:55], v[24:27], v[12:15], v[52:55]
    v_perm_b32 v12, v103, v99, s73
    v_perm_b32 v13, v111, v107, s73
    v_perm_b32 v14, v119, v115, s73
    v_perm_b32 v15, v127, v123, s73
    v_mfma_f32_16x16x32_bf16 v[56:59], v[24:27], v[8:11], v[56:59]
    s_nop 0
    v_mfma_f32_16x16x32_bf16 v[60:63], v[24:27], v[12:15], v[60:63]
    v_bfe_u32 v4, v0, 4, 1
    v_lshlrev_b32 v4, 11, v4
    v_and_b32 v5, 15, v0
    v_lshl_or_b32 v4, v5, 5, v4
    v_lshrrev_b32 v5, 5, v0
    v_lshl_or_b32 v4, v5, 4, v4
    s_lshl_b32 s76, s68, 12
    v_add_u32 v4, s76, v4
    s_waitcnt vmcnt(0)
    s_add_u32 s80, s59, 229376
    buffer_load_dwordx4 v[144:147], v2, s[36:39], s80 offen nt
    buffer_load_dwordx4 v[148:151], v2, s[36:39], s80 offen offset:1024 nt
    s_add_u32 s80, s59, 229376
    buffer_load_dwordx4 v[152:155], v2, s[36:39], s80 offen offset:2048 nt
    buffer_load_dwordx4 v[156:159], v2, s[36:39], s80 offen offset:3072 nt
    s_barrier
    s_cmp_ge_u32 s68, 4
    s_cbranch_scc1 L_preG
    s_lshr_b32 s78, s68, 1
    s_and_b32 s79, s68, 1
    s_lshl_b32 s3, s78, 17
    s_lshl_b32 s76, s79, 8
    s_add_u32 s3, s3, s76
    s_add_u32 s80, s3, 0
    buffer_load_dwordx4 v[160:163], v1, s[44:47], s80 offen nt
    buffer_load_dwordx4 v[164:167], v1, s[44:47], s80 offen offset:2048 nt
    s_add_u32 s80, s3, 4096
    buffer_load_dwordx4 v[168:171], v1, s[44:47], s80 offen nt
    buffer_load_dwordx4 v[172:175], v1, s[44:47], s80 offen offset:2048 nt
    v_mov_b32 v7, 0
    s_mov_b32 s82, 0x100000
L_wsm:
    ds_read_b32 v6, v7 offset:34964
    s_waitcnt lgkmcnt(0)
    v_readfirstlane_b32 s76, v6
    s_cmp_ge_u32 s76, 8
    s_cbranch_scc1 L_wsm_ok
    s_sleep 1
    s_sub_u32 s82, s82, 1
    s_cmp_lg_u32 s82, 0
    s_cbranch_scc1 L_wsm
L_wsm_ok:
    s_lshl_b32 s76, s68, 6
    v_lshlrev_b32 v6, 5, v5
    v_add_u32 v6, s76, v6
    ds_read_b128 v[224:227], v6 offset:35072
    ds_read_b128 v[228:231], v6 offset:35088
    s_lshl_b32 s76, s68, 10
    v_add_u32 v5, s76, v2
    v_and_b32 v248, 3, v0
    v_mul_u32_u24 v248, 272, v248
    v_lshrrev_b32 v7, 4, v0
    v_lshl_add_u32 v248, v7, 4, v248
    s_lshl_b32 s76, s78, 7
    v_add_u32 v248, s76, v248
    v_mul_u32_u24 v249, 144, v0
    s_mul_i32 s76, s78, 4608
    s_mul_i32 s77, s79, 2304
    s_add_u32 s76, s76, s77
    v_add_u32 v249, s76, v249
    v_lshrrev_b32 v250, 2, v0
    v_and_b32 v7, 3, v0
    v_lshlrev_b32 v7, 4, v7
    v_lshl_or_b32 v250, v250, 12, v7
    v_lshrrev_b32 v251, 3, v0
    v_lshl_add_u32 v251, v251, 4, v2
    s_mul_i32 s77, s68, 1152
    v_add_u32 v251, s77, v251
    s_lshl_b32 s78, s89, 18
    s_lshl_b32 s77, s68, 16
    s_add_u32 s78, s78, s77
    s_lshl_b32 s77, s69, 9
    s_add_u32 s78, s78, s77
    s_lshl_b32 s77, s88, 6
    s_add_u32 s78, s78, s77
    s_add_u32 s78, s78, 0x300000
    s_add_u32 s79, s74, 0x300000
    s_waitcnt lgkmcnt(0)
    v_max3_f32 v6, v224, v225, v226
    v_max3_f32 v6, v6, v227, v228
    v_max3_f32 v6, v6, v229, v230
    v_max_f32 v6, v6, v231
    v_sub_f32 v224, v224, v6
    v_sub_f32 v225, v225, v6
    v_sub_f32 v226, v226, v6
    v_sub_f32 v227, v227, v6
    v_sub_f32 v228, v228, v6
    v_sub_f32 v229, v229, v6
    v_sub_f32 v230, v230, v6
    v_sub_f32 v231, v231, v6
    v_exp_f32 v224, v224
    v_exp_f32 v225, v225
    v_exp_f32 v226, v226
    v_exp_f32 v227, v227
    v_exp_f32 v228, v228
    v_exp_f32 v229, v229
    v_exp_f32 v230, v230
    v_exp_f32 v231, v231
    s_waitcnt vmcnt(4)
    s_add_u32 s80, s3, 8192
    buffer_load_dwordx4 v[176:179], v1, s[44:47], s80 offen nt
    buffer_load_dwordx4 v[180:183], v1, s[44:47], s80 offen offset:2048 nt
    s_add_u32 s80, s3, 12288
    buffer_load_dwordx4 v[184:187], v1, s[44:47], s80 offen nt
    buffer_load_dwordx4 v[188:191], v1, s[44:47], s80 offen offset:2048 nt
    s_branch L_pv3
L_preG:
    v_lshrrev_b32 v248, 3, v0
    v_and_b32 v5, 7, v0
    v_lshlrev_b32 v6, 4, v5
    v_lshl_or_b32 v248, v248, 12, v6
    v_add_u32 v249, 3145728, v248
    s_lshl_b32 s76, s69, 17
    s_lshl_b32 s78, s88, 9
    s_add_u32 s76, s76, s78
    s_lshl_b32 s78, s90, 7
    s_add_u32 s76, s76, s78
    s_add_u32 s76, s76, 0x100000
    s_add_u32 s78, s76, 32768
    s_add_u32 s79, s76, 65536
    s_add_u32 s81, s76, 98304
    v_lshrrev_b32 v7, 4, v0
    v_mul_u32_u24 v250, 272, v7
    v_lshl_add_u32 v250, v5, 3, v250
    s_lshl_b32 s77, s90, 6
    v_add_u32 v250, s77, v250
    s_waitcnt vmcnt(4)
    s_mov_b32 s82, 0x10000
L_spin1:
    v_xor_b32 v193, s56, v193
    v_xor_b32 v195, s86, v195
    v_xor_b32 v197, s56, v197
    v_xor_b32 v199, s86, v199
    v_xor_b32 v201, s56, v201
    v_xor_b32 v203, s86, v203
    v_xor_b32 v205, s56, v205
    v_xor_b32 v207, s86, v207
    v_or3_b32 v217, v193, v197, v201
    v_or3_b32 v218, v195, v199, v203
    v_or_b32 v218, v218, v207
    v_lshrrev_b32 v219, 4, v218
    v_or3_b32 v219, v219, v217, v205
    v_cmp_ne_u32 vcc, 0, v219
    s_cbranch_vccz L_ml_ok
    s_sleep 8
    buffer_load_dwordx4 v[192:195], v216, s[52:55], s95 offen sc1
    buffer_load_dwordx4 v[196:199], v216, s[52:55], s95 offen offset:1024 sc1
    buffer_load_dwordx4 v[200:203], v216, s[52:55], s95 offen offset:2048 sc1
    buffer_load_dwordx4 v[204:207], v216, s[52:55], s95 offen offset:3072 sc1
    s_waitcnt vmcnt(0)
    s_sub_u32 s82, s82, 1
    s_cmp_lg_u32 s82, 0
    s_cbranch_scc1 L_spin1
L_ml_ok:
    v_cmp_ne_u32 vcc, 0, v218
    s_cmp_eq_u64 vcc, 0
    s_cselect_b32 s87, 1, 0
    v_mov_b32 v217, v192
    s_nop 1
    v_max_f32_dpp v218, v217, v217 row_ror:8 row_mask:0xf bank_mask:0xf
    v_mov_b32 v217, v218
    s_nop 1
    v_permlane16_swap_b32 v217, v218
    v_max_f32 v217, v217, v218
    v_mov_b32 v218, v217
    s_nop 1
    v_permlane32_swap_b32 v217, v218
    v_max_f32 v217, v217, v218
    v_sub_f32 v192, v192, v217
    v_exp_f32 v192, v192
    s_nop 0
    v_mul_f32 v194, v194, v192
    s_nop 1
    v_add_f32_dpp v218, v194, v194 row_ror:8 row_mask:0xf bank_mask:0xf
    v_mov_b32 v194, v218
    s_nop 1
    v_permlane16_swap_b32 v194, v218
    v_add_f32 v194, v194, v218
    v_mov_b32 v218, v194
    s_nop 1
    v_permlane32_swap_b32 v194, v218
    v_add_f32 v194, v194, v218
    v_rcp_f32 v194, v194
    s_nop 0
    v_mul_f32 v224, v192, v194
    v_mov_b32 v217, v196
    s_nop 1
    v_max_f32_dpp v218, v217, v217 row_ror:8 row_mask:0xf bank_mask:0xf
    v_mov_b32 v217, v218
    s_nop 1
    v_permlane16_swap_b32 v217, v218
    v_max_f32 v217, v217, v218
    v_mov_b32 v218, v217
    s_nop 1
    v_permlane32_swap_b32 v217, v218
    v_max_f32 v217, v217, v218
    v_sub_f32 v196, v196, v217
    v_exp_f32 v196, v196
    s_nop 0
    v_mul_f32 v198, v198, v196
    s_nop 1
    v_add_f32_dpp v218, v198, v198 row_ror:8 row_mask:0xf bank_mask:0xf
    v_mov_b32 v198, v218
    s_nop 1
    v_permlane16_swap_b32 v198, v218
    v_add_f32 v198, v198, v218
    v_mov_b32 v218, v198
    s_nop 1
    v_permlane32_swap_b32 v198, v218
    v_add_f32 v198, v198, v218
    v_rcp_f32 v198, v198
    s_nop 0
    v_mul_f32 v225, v196, v198
    v_mov_b32 v217, v200
    s_nop 1
    v_max_f32_dpp v218, v217, v217 row_ror:8 row_mask:0xf bank_mask:0xf
    v_mov_b32 v217, v218
    s_nop 1
    v_permlane16_swap_b32 v217, v218
    v_max_f32 v217, v217, v218
    v_mov_b32 v218, v217
    s_nop 1
    v_permlane32_swap_b32 v217, v218
    v_max_f32 v217, v217, v218
    v_sub_f32 v200, v200, v217
    v_exp_f32 v200, v200
    s_nop 0
    v_mul_f32 v202, v202, v200
    s_nop 1
    v_add_f32_dpp v218, v202, v202 row_ror:8 row_mask:0xf bank_mask:0xf
    v_mov_b32 v202, v218
    s_nop 1
    v_permlane16_swap_b32 v202, v218
    v_add_f32 v202, v202, v218
    v_mov_b32 v218, v202
    s_nop 1
    v_permlane32_swap_b32 v202, v218
    v_add_f32 v202, v202, v218
    v_rcp_f32 v202, v202
    s_nop 0
    v_mul_f32 v226, v200, v202
    v_mov_b32 v217, v204
    s_nop 1
    v_max_f32_dpp v218, v217, v217 row_ror:8 row_mask:0xf bank_mask:0xf
    v_mov_b32 v217, v218
    s_nop 1
    v_permlane16_swap_b32 v217, v218
    v_max_f32 v217, v217, v218
    v_mov_b32 v218, v217
    s_nop 1
    v_permlane32_swap_b32 v217, v218
    v_max_f32 v217, v217, v218
    v_sub_f32 v204, v204, v217
    v_exp_f32 v204, v204
    s_nop 0
    v_mul_f32 v206, v206, v204
    s_nop 1
    v_add_f32_dpp v218, v206, v206 row_ror:8 row_mask:0xf bank_mask:0xf
    v_mov_b32 v206, v218
    s_nop 1
    v_permlane16_swap_b32 v206, v218
    v_add_f32 v206, v206, v218
    v_mov_b32 v218, v206
    s_nop 1
    v_permlane32_swap_b32 v206, v218
    v_add_f32 v206, v206, v218
    v_rcp_f32 v206, v206
    s_nop 0
    v_mul_f32 v227, v204, v206
    s_waitcnt vmcnt(0)
L_pv3:
    v_perm_b32 v8, v132, v128, s72
    v_perm_b32 v9, v140, v136, s72
    v_perm_b32 v10, v148, v144, s72
    v_perm_b32 v11, v156, v152, s72
    v_perm_b32 v12, v132, v128, s73
    v_perm_b32 v13, v140, v136, s73
    v_perm_b32 v14, v148, v144, s73
    v_perm_b32 v15, v156, v152, s73
    v_mfma_f32_16x16x32_bf16 v[32:35], v[28:31], v[8:11], v[32:35]
    v_perm_b32 v8, v133, v129, s72
    v_perm_b32 v9, v141, v137, s72
    v_perm_b32 v10, v149, v145, s72
    v_perm_b32 v11, v157, v153, s72
    v_mfma_f32_16x16x32_bf16 v[36:39], v[28:31], v[12:15], v[36:39]
    v_perm_b32 v12, v133, v129, s73
    v_perm_b32 v13, v141, v137, s73
    v_perm_b32 v14, v149, v145, s73
    v_perm_b32 v15, v157, v153, s73
    v_mfma_f32_16x16x32_bf16 v[40:43], v[28:31], v[8:11], v[40:43]
    v_perm_b32 v8, v134, v130, s72
    v_perm_b32 v9, v142, v138, s72
    v_perm_b32 v10, v150, v146, s72
    v_perm_b32 v11, v158, v154, s72
    v_mfma_f32_16x16x32_bf16 v[44:47], v[28:31], v[12:15], v[44:47]
    v_perm_b32 v12, v134, v130, s73
    v_perm_b32 v13, v142, v138, s73
    v_perm_b32 v14, v150, v146, s73
    v_perm_b32 v15, v158, v154, s73
    v_mfma_f32_16x16x32_bf16 v[48:51], v[28:31], v[8:11], v[48:51]
    v_perm_b32 v8, v135, v131, s72
    v_perm_b32 v9, v143, v139, s72
    v_perm_b32 v10, v151, v147, s72
    v_perm_b32 v11, v159, v155, s72
    v_mfma_f32_16x16x32_bf16 v[52:55], v[28:31], v[12:15], v[52:55]
    v_perm_b32 v12, v135, v131, s73
    v_perm_b32 v13, v143, v139, s73
    v_perm_b32 v14, v151, v147, s73
    v_perm_b32 v15, v159, v155, s73
    v_mfma_f32_16x16x32_bf16 v[56:59], v[28:31], v[8:11], v[56:59]
    s_nop 0
    v_mfma_f32_16x16x32_bf16 v[60:63], v[28:31], v[12:15], v[60:63]
    v_permlane32_swap_b32 v32, v48
    v_permlane32_swap_b32 v33, v49
    v_permlane32_swap_b32 v34, v50
    v_permlane32_swap_b32 v35, v51
    v_permlane32_swap_b32 v36, v52
    v_permlane32_swap_b32 v37, v53
    v_permlane32_swap_b32 v38, v54
    v_permlane32_swap_b32 v39, v55
    v_permlane32_swap_b32 v40, v56
    v_permlane32_swap_b32 v41, v57
    v_permlane32_swap_b32 v42, v58
    v_permlane32_swap_b32 v43, v59
    v_permlane32_swap_b32 v44, v60
    v_permlane32_swap_b32 v45, v61
    v_permlane32_swap_b32 v46, v62
    v_permlane32_swap_b32 v47, v63
    v_add_f32 v16, v32, v48
    v_add_f32 v17, v36, v52
    v_add_f32 v18, v40, v56
    v_add_f32 v19, v44, v60
    ds_write_b128 v4, v[16:19]
    v_add_f32 v20, v33, v49
    v_add_f32 v21, v37, v53
    v_add_f32 v22, v41, v57
    v_add_f32 v23, v45, v61
    ds_write_b128 v4, v[20:23] offset:512
    v_add_f32 v24, v34, v50
    v_add_f32 v25, v38, v54
    v_add_f32 v26, v42, v58
    v_add_f32 v27, v46, v62
    ds_write_b128 v4, v[24:27] offset:1024
    v_add_f32 v28, v35, v51
    v_add_f32 v29, v39, v55
    v_add_f32 v30, v43, v59
    v_add_f32 v31, v47, v63
    ds_write_b128 v4, v[28:31] offset:1536
    s_waitcnt lgkmcnt(0)
    s_barrier
    s_cmp_ge_u32 s68, 4
    s_cbranch_scc1 L_gath
    ds_read_b128 v[96:99], v5
    ds_read_b128 v[100:103], v5 offset:4096
    ds_read_b128 v[104:107], v5 offset:8192
    ds_read_b128 v[108:111], v5 offset:12288
    ds_read_b128 v[112:115], v5 offset:16384
    ds_read_b128 v[116:119], v5 offset:20480
    ds_read_b128 v[120:123], v5 offset:24576
    ds_read_b128 v[124:127], v5 offset:28672
    s_waitcnt lgkmcnt(6)
    v_mul_f32 v96, v96, v224
    v_mul_f32 v97, v97, v224
    v_mul_f32 v98, v98, v224
    v_mul_f32 v99, v99, v224
    v_mul_f32 v100, v100, v225
    v_mul_f32 v101, v101, v225
    v_mul_f32 v102, v102, v225
    v_mul_f32 v103, v103, v225
    s_waitcnt lgkmcnt(4)
    v_fma_f32 v96, v104, v226, v96
    v_fma_f32 v97, v105, v226, v97
    v_fma_f32 v98, v106, v226, v98
    v_fma_f32 v99, v107, v226, v99
    v_fma_f32 v100, v108, v227, v100
    v_fma_f32 v101, v109, v227, v101
    v_fma_f32 v102, v110, v227, v102
    v_fma_f32 v103, v111, v227, v103
    s_waitcnt lgkmcnt(2)
    v_fma_f32 v96, v112, v228, v96
    v_fma_f32 v97, v113, v228, v97
    v_fma_f32 v98, v114, v228, v98
    v_fma_f32 v99, v115, v228, v99
    v_fma_f32 v100, v116, v229, v100
    v_fma_f32 v101, v117, v229, v101
    v_fma_f32 v102, v118, v229, v102
    v_fma_f32 v103, v119, v229, v103
    s_waitcnt lgkmcnt(0)
    v_fma_f32 v96, v120, v230, v96
    v_fma_f32 v97, v121, v230, v97
    v_fma_f32 v98, v122, v230, v98
    v_fma_f32 v99, v123, v230, v99
    v_fma_f32 v100, v124, v231, v100
    v_fma_f32 v101, v125, v231, v101
    v_fma_f32 v102, v126, v231, v102
    v_fma_f32 v103, v127, v231, v103
    v_add_f32 v96, v96, v100
    v_add_f32 v97, v97, v101
    v_add_f32 v98, v98, v102
    v_add_f32 v99, v99, v103
    v_add_u32 v96, 2048, v96
    v_bfi_b32 v96, s29, v96, v3
    v_add_u32 v97, 2048, v97
    v_bfi_b32 v97, s29, v97, v3
    v_add_u32 v98, 2048, v98
    v_bfi_b32 v98, s29, v98, v3
    v_add_u32 v99, 2048, v99
    v_bfi_b32 v99, s29, v99, v3
    buffer_store_dwordx4 v[96:99], v2, s[52:55], s79 offen
    buffer_store_dwordx4 v[96:99], v2, s[52:55], s74 offen sc1
    s_add_u32 s80, s3, 65536
    buffer_load_dwordx4 v[192:195], v1, s[44:47], s80 offen nt
    buffer_load_dwordx4 v[196:199], v1, s[44:47], s80 offen offset:2048 nt
    s_add_u32 s80, s3, 69632
    buffer_load_dwordx4 v[200:203], v1, s[44:47], s80 offen nt
    buffer_load_dwordx4 v[204:207], v1, s[44:47], s80 offen offset:2048 nt
    s_add_u32 s80, s3, 73728
    buffer_load_dwordx4 v[208:211], v1, s[44:47], s80 offen nt
    buffer_load_dwordx4 v[212:215], v1, s[44:47], s80 offen offset:2048 nt
    s_add_u32 s80, s3, 77824
    buffer_load_dwordx4 v[216:219], v1, s[44:47], s80 offen nt
    buffer_load_dwordx4 v[220:223], v1, s[44:47], s80 offen offset:2048 nt
    s_waitcnt vmcnt(10)
    v_perm_b32 v64, v164, v160, s72
    v_perm_b32 v65, v172, v168, s72
    v_perm_b32 v66, v180, v176, s72
    v_perm_b32 v67, v188, v184, s72
    v_perm_b32 v68, v164, v160, s73
    v_perm_b32 v69, v172, v168, s73
    v_perm_b32 v70, v180, v176, s73
    v_perm_b32 v71, v188, v184, s73
    v_perm_b32 v72, v165, v161, s72
    v_perm_b32 v73, v173, v169, s72
    v_perm_b32 v74, v181, v177, s72
    v_perm_b32 v75, v189, v185, s72
    v_perm_b32 v76, v165, v161, s73
    v_perm_b32 v77, v173, v169, s73
    v_perm_b32 v78, v181, v177, s73
    v_perm_b32 v79, v189, v185, s73
    v_perm_b32 v80, v166, v162, s72
    v_perm_b32 v81, v174, v170, s72
    v_perm_b32 v82, v182, v178, s72
    v_perm_b32 v83, v190, v186, s72
    v_perm_b32 v84, v166, v162, s73
    v_perm_b32 v85, v174, v170, s73
    v_perm_b32 v86, v182, v178, s73
    v_perm_b32 v87, v190, v186, s73
    v_perm_b32 v88, v167, v163, s72
    v_perm_b32 v89, v175, v171, s72
    v_perm_b32 v90, v183, v179, s72
    v_perm_b32 v91, v191, v187, s72
    v_perm_b32 v92, v167, v163, s73
    v_perm_b32 v93, v175, v171, s73
    v_perm_b32 v94, v183, v179, s73
    v_perm_b32 v95, v191, v187, s73
    s_waitcnt vmcnt(0)
    v_perm_b32 v128, v196, v192, s72
    v_perm_b32 v129, v204, v200, s72
    v_perm_b32 v130, v212, v208, s72
    v_perm_b32 v131, v220, v216, s72
    v_perm_b32 v132, v196, v192, s73
    v_perm_b32 v133, v204, v200, s73
    v_perm_b32 v134, v212, v208, s73
    v_perm_b32 v135, v220, v216, s73
    v_perm_b32 v136, v197, v193, s72
    v_perm_b32 v137, v205, v201, s72
    v_perm_b32 v138, v213, v209, s72
    v_perm_b32 v139, v221, v217, s72
    v_perm_b32 v140, v197, v193, s73
    v_perm_b32 v141, v205, v201, s73
    v_perm_b32 v142, v213, v209, s73
    v_perm_b32 v143, v221, v217, s73
    v_perm_b32 v144, v198, v194, s72
    v_perm_b32 v145, v206, v202, s72
    v_perm_b32 v146, v214, v210, s72
    v_perm_b32 v147, v222, v218, s72
    v_perm_b32 v148, v198, v194, s73
    v_perm_b32 v149, v206, v202, s73
    v_perm_b32 v150, v214, v210, s73
    v_perm_b32 v151, v222, v218, s73
    v_perm_b32 v152, v199, v195, s72
    v_perm_b32 v153, v207, v203, s72
    v_perm_b32 v154, v215, v211, s72
    v_perm_b32 v155, v223, v219, s72
    v_perm_b32 v156, v199, v195, s73
    v_perm_b32 v157, v207, v203, s73
    v_perm_b32 v158, v215, v211, s73
    v_perm_b32 v159, v223, v219, s73
    s_branch L_s5
L_gath:
    s_mov_b32 s82, 0x10000
L_ap_loop:
    s_cmp_eq_u32 s87, 0
    s_cbranch_scc1 L_ap_safe
    s_mov_b32 s80, 12
L_ap_fast:
    buffer_load_dwordx4 v[232:235], v249, s[52:55], s76 offen sc1
    buffer_load_dwordx4 v[236:239], v249, s[52:55], s78 offen sc1
    buffer_load_dwordx4 v[240:243], v249, s[52:55], s79 offen sc1
    buffer_load_dwordx4 v[244:247], v249, s[52:55], s81 offen sc1
    s_waitcnt vmcnt(0)
    v_xor_b32 v232, s28, v232
    v_xor_b32 v233, s28, v233
    v_xor_b32 v234, s28, v234
    v_xor_b32 v235, s28, v235
    v_xor_b32 v236, s28, v236
    v_xor_b32 v237, s28, v237
    v_xor_b32 v238, s28, v238
    v_xor_b32 v239, s28, v239
    v_xor_b32 v240, s28, v240
    v_xor_b32 v241, s28, v241
    v_xor_b32 v242, s28, v242
    v_xor_b32 v243, s28, v243
    v_xor_b32 v244, s28, v244
    v_xor_b32 v245, s28, v245
    v_xor_b32 v246, s28, v246
    v_xor_b32 v247, s28, v247
    v_or3_b32 v6, v232, v233, v234
    v_or3_b32 v6, v6, v235, v236
    v_or3_b32 v6, v6, v237, v238
    v_or3_b32 v6, v6, v239, v240
    v_or3_b32 v6, v6, v241, v242
    v_or3_b32 v6, v6, v243, v244
    v_or3_b32 v6, v6, v245, v246
    v_or_b32 v6, v6, v247
    v_and_b32 v6, 4095, v6
    v_cmp_ne_u32 vcc, 0, v6
    s_cbranch_vccz L_ap_ok
    s_mov_b64 exec, vcc
    s_sub_u32 s80, s80, 1
    s_cmp_lg_u32 s80, 0
    s_cbranch_scc1 L_ap_fast
L_ap_safe:
    buffer_load_dwordx4 v[232:235], v248, s[52:55], s76 offen sc1
    buffer_load_dwordx4 v[236:239], v248, s[52:55], s78 offen sc1
    buffer_load_dwordx4 v[240:243], v248, s[52:55], s79 offen sc1
    buffer_load_dwordx4 v[244:247], v248, s[52:55], s81 offen sc1
    s_waitcnt vmcnt(0)
    v_xor_b32 v232, s28, v232
    v_xor_b32 v233, s28, v233
    v_xor_b32 v234, s28, v234
    v_xor_b32 v235, s28, v235
    v_xor_b32 v236, s28, v236
    v_xor_b32 v237, s28, v237
    v_xor_b32 v238, s28, v238
    v_xor_b32 v239, s28, v239
    v_xor_b32 v240, s28, v240
    v_xor_b32 v241, s28, v241
    v_xor_b32 v242, s28, v242
    v_xor_b32 v243, s28, v243
    v_xor_b32 v244, s28, v244
    v_xor_b32 v245, s28, v245
    v_xor_b32 v246, s28, v246
    v_xor_b32 v247, s28, v247
    v_or3_b32 v6, v232, v233, v234
    v_or3_b32 v6, v6, v235, v236
    v_or3_b32 v6, v6, v237, v238
    v_or3_b32 v6, v6, v239, v240
    v_or3_b32 v6, v6, v241, v242
    v_or3_b32 v6, v6, v243, v244
    v_or3_b32 v6, v6, v245, v246
    v_or_b32 v6, v6, v247
    v_and_b32 v6, 4095, v6
    v_cmp_ne_u32 vcc, 0, v6
    s_cbranch_vccz L_ap_ok
    s_mov_b64 exec, vcc
    s_sub_u32 s82, s82, 1
    s_cmp_lg_u32 s82, 0
    s_cbranch_scc1 L_ap_loop
L_ap_ok:
    s_mov_b64 exec, -1
    v_mul_f32 v232, v232, v224
    v_mul_f32 v233, v233, v224
    v_mul_f32 v234, v234, v224
    v_mul_f32 v235, v235, v224
    v_mul_f32 v236, v236, v225
    v_mul_f32 v237, v237, v225
    v_mul_f32 v238, v238, v225
    v_mul_f32 v239, v239, v225
    v_mul_f32 v240, v240, v226
    v_mul_f32 v241, v241, v226
    v_mul_f32 v242, v242, v226
    v_mul_f32 v243, v243, v226
    v_mul_f32 v244, v244, v227
    v_mul_f32 v245, v245, v227
    v_mul_f32 v246, v246, v227
    v_mul_f32 v247, v247, v227
    v_permlane32_swap_b32 v232, v240
    v_permlane32_swap_b32 v233, v241
    v_permlane32_swap_b32 v234, v242
    v_permlane32_swap_b32 v235, v243
    v_permlane32_swap_b32 v236, v244
    v_permlane32_swap_b32 v237, v245
    v_permlane32_swap_b32 v238, v246
    v_permlane32_swap_b32 v239, v247
    v_add_f32 v232, v232, v240
    v_add_f32 v233, v233, v241
    v_add_f32 v234, v234, v242
    v_add_f32 v235, v235, v243
    v_add_f32 v236, v236, v244
    v_add_f32 v237, v237, v245
    v_add_f32 v238, v238, v246
    v_add_f32 v239, v239, v247
    v_permlane16_swap_b32 v232, v236
    v_permlane16_swap_b32 v233, v237
    v_permlane16_swap_b32 v234, v238
    v_permlane16_swap_b32 v235, v239
    v_add_f32 v232, v232, v236
    v_add_f32 v233, v233, v237
    v_add_f32 v234, v234, v238
    v_add_f32 v235, v235, v239
    v_add_f32_dpp v236, v232, v232 row_ror:8 row_mask:0xf bank_mask:0xf
    v_add_f32_dpp v237, v233, v233 row_ror:8 row_mask:0xf bank_mask:0xf
    v_add_f32_dpp v238, v234, v234 row_ror:8 row_mask:0xf bank_mask:0xf
    v_add_f32_dpp v239, v235, v235 row_ror:8 row_mask:0xf bank_mask:0xf
    v_cvt_pk_bf16_f32 v232, v236, v237
    v_cvt_pk_bf16_f32 v233, v238, v239
    ds_write_b64 v250, v[232:233] offset:35584
L_s5:
    s_waitcnt lgkmcnt(0)
    s_barrier
    s_cmp_ge_u32 s68, 4
    s_cbranch_scc1 L_s6
    ds_read_b128 v[8:11], v248 offset:35584
    ds_read_b128 v[12:15], v248 offset:35648
    s_waitcnt lgkmcnt(1)
    v_mfma_f32_16x16x32_bf16 v[32:35], v[8:11], v[64:67], 0
    v_mfma_f32_16x16x32_bf16 v[36:39], v[8:11], v[68:71], 0
    v_mfma_f32_16x16x32_bf16 v[40:43], v[8:11], v[72:75], 0
    v_mfma_f32_16x16x32_bf16 v[44:47], v[8:11], v[76:79], 0
    v_mfma_f32_16x16x32_bf16 v[48:51], v[8:11], v[80:83], 0
    v_mfma_f32_16x16x32_bf16 v[52:55], v[8:11], v[84:87], 0
    v_mfma_f32_16x16x32_bf16 v[56:59], v[8:11], v[88:91], 0
    v_mfma_f32_16x16x32_bf16 v[60:63], v[8:11], v[92:95], 0
    s_waitcnt lgkmcnt(0)
    v_mfma_f32_16x16x32_bf16 v[32:35], v[12:15], v[128:131], v[32:35]
    v_mfma_f32_16x16x32_bf16 v[36:39], v[12:15], v[132:135], v[36:39]
    v_mfma_f32_16x16x32_bf16 v[40:43], v[12:15], v[136:139], v[40:43]
    v_mfma_f32_16x16x32_bf16 v[44:47], v[12:15], v[140:143], v[44:47]
    v_mfma_f32_16x16x32_bf16 v[48:51], v[12:15], v[144:147], v[48:51]
    v_mfma_f32_16x16x32_bf16 v[52:55], v[12:15], v[148:151], v[52:55]
    v_mfma_f32_16x16x32_bf16 v[56:59], v[12:15], v[152:155], v[56:59]
    v_mfma_f32_16x16x32_bf16 v[60:63], v[12:15], v[156:159], v[60:63]
    s_mov_b64 exec, 0xffff
    ds_write_b128 v249, v[32:35] offset:36864
    ds_write_b128 v249, v[36:39] offset:36880
    ds_write_b128 v249, v[40:43] offset:36896
    ds_write_b128 v249, v[44:47] offset:36912
    ds_write_b128 v249, v[48:51] offset:36928
    ds_write_b128 v249, v[52:55] offset:36944
    ds_write_b128 v249, v[56:59] offset:36960
    ds_write_b128 v249, v[60:63] offset:36976
    s_mov_b64 exec, -1
L_s6:
    s_waitcnt lgkmcnt(0)
    s_barrier
    s_cmp_ge_u32 s68, 4
    s_cbranch_scc1 L_not7
    ds_read_b128 v[96:99], v251 offset:36864
    ds_read_b128 v[100:103], v251 offset:41472
    s_waitcnt lgkmcnt(0)
    v_add_f32 v96, v96, v100
    v_add_f32 v97, v97, v101
    v_add_f32 v98, v98, v102
    v_add_f32 v99, v99, v103
    v_add_u32 v96, 2048, v96
    v_bfi_b32 v96, s29, v96, v3
    v_add_u32 v97, 2048, v97
    v_bfi_b32 v97, s29, v97, v3
    v_add_u32 v98, 2048, v98
    v_bfi_b32 v98, s29, v98, v3
    v_add_u32 v99, 2048, v99
    v_bfi_b32 v99, s29, v99, v3
    buffer_store_dwordx4 v[96:99], v250, s[52:55], s78 offen sc1
L_not7:
    s_cmp_lg_u32 s68, 7
    s_cbranch_scc1 L_fin
    s_waitcnt vmcnt(0)
    s_lshl_b32 s76, s2, 12
    s_add_u32 s76, s76, 0x300000
    buffer_load_dwordx4 v[160:163], v2, s[52:55], s76 offen sc1
    buffer_load_dwordx4 v[164:167], v2, s[52:55], s76 offen offset:1024 sc1
    buffer_load_dwordx4 v[168:171], v2, s[52:55], s76 offen offset:2048 sc1
    buffer_load_dwordx4 v[172:175], v2, s[52:55], s76 offen offset:3072 sc1
    s_mov_b64 s[14:15], -1
    v_lshrrev_b32 v4, 4, v0
    v_lshlrev_b32 v5, 5, v4
    ds_read_b128 v[32:35], v5 offset:36720
    ds_read_b128 v[36:39], v5 offset:36736
    v_and_b32 v7, 3, v0
    v_lshlrev_b32 v7, 1, v7
    v_lshl_or_b32 v5, v4, 11, v7
    v_and_b32 v7, 15, v0
    v_cmp_eq_u32 vcc, 0, v7
    v_mov_b32 v7, 2147483648
    s_nop 0
    v_cndmask_b32 v5, v7, v5, vcc
    s_lshl_b32 s77, s2, 3
    s_waitcnt lgkmcnt(0)
    v_add_f32 v6, v32, v33
    v_add_f32 v6, v6, v34
    v_add_f32 v6, v6, v35
    v_add_f32 v6, v6, v36
    v_add_f32 v6, v6, v37
    v_add_f32 v6, v6, v38
    v_add_f32 v6, v6, v39
    v_cvt_pk_bf16_f32 v6, v6, v6
    v_and_b32 v6, 4294901760, v6
    v_mul_f32 v6, s94, v6
    v_exp_f32 v6, -v6
    s_nop 0
    v_add_f32 v6, 1.0, v6
    v_rcp_f32 v6, v6
    s_nop 0
    v_cvt_pk_bf16_f32 v6, v6, v6
    v_and_b32 v6, 4294901760, v6
    v_sub_f32 v7, 1.0, v6
    v_cvt_pk_bf16_f32 v7, v7, v7
    v_and_b32 v7, 4294901760, v7
    s_mov_b32 s82, 0x10000
L_op_loop:
    s_waitcnt vmcnt(0)
    s_mov_b64 exec, s[14:15]
    v_xor_b32 v160, s28, v160
    v_xor_b32 v161, s28, v161
    v_xor_b32 v162, s28, v162
    v_xor_b32 v163, s28, v163
    v_xor_b32 v164, s28, v164
    v_xor_b32 v165, s28, v165
    v_xor_b32 v166, s28, v166
    v_xor_b32 v167, s28, v167
    v_xor_b32 v168, s28, v168
    v_xor_b32 v169, s28, v169
    v_xor_b32 v170, s28, v170
    v_xor_b32 v171, s28, v171
    v_xor_b32 v172, s28, v172
    v_xor_b32 v173, s28, v173
    v_xor_b32 v174, s28, v174
    v_xor_b32 v175, s28, v175
    v_or3_b32 v10, v160, v161, v162
    v_or3_b32 v10, v10, v163, v164
    v_or3_b32 v10, v10, v165, v166
    v_or3_b32 v10, v10, v167, v168
    v_or3_b32 v10, v10, v169, v170
    v_or3_b32 v10, v10, v171, v172
    v_or3_b32 v10, v10, v173, v174
    v_or_b32 v10, v10, v175
    v_and_b32 v10, 4095, v10
    v_cmp_ne_u32 vcc, 0, v10
    s_cbranch_vccz L_op_d0
    s_mov_b64 s[14:15], vcc
    s_mov_b64 exec, vcc
    buffer_load_dwordx4 v[160:163], v2, s[52:55], s76 offen sc1
    buffer_load_dwordx4 v[164:167], v2, s[52:55], s76 offen offset:1024 sc1
    buffer_load_dwordx4 v[168:171], v2, s[52:55], s76 offen offset:2048 sc1
    buffer_load_dwordx4 v[172:175], v2, s[52:55], s76 offen offset:3072 sc1
    s_sub_u32 s82, s82, 1
    s_cmp_lg_u32 s82, 0
    s_cbranch_scc1 L_op_loop
L_op_d0:
    s_mov_b64 exec, -1
    v_add_f32 v64, v160, v164
    v_add_f32 v72, v168, v172
    v_add_f32 v65, v161, v165
    v_add_f32 v73, v169, v173
    v_add_f32 v66, v162, v166
    v_add_f32 v74, v170, v174
    v_add_f32 v67, v163, v167
    v_add_f32 v75, v171, v175
L_op_ok:
    v_permlane32_swap_b32 v64, v72
    v_permlane32_swap_b32 v65, v73
    v_permlane32_swap_b32 v66, v74
    v_permlane32_swap_b32 v67, v75
    v_add_f32 v64, v64, v72
    v_add_f32 v65, v65, v73
    v_add_f32 v66, v66, v74
    v_add_f32 v67, v67, v75
    v_permlane16_swap_b32 v64, v65
    s_nop 0
    v_permlane16_swap_b32 v66, v67
    v_add_f32 v64, v64, v65
    v_add_f32 v66, v66, v67
    s_nop 0
    v_add_f32_dpp v68, v64, v64 row_ror:8 row_mask:0xf bank_mask:0xf
    v_add_f32_dpp v67, v66, v66 row_ror:8 row_mask:0xf bank_mask:0xf
    s_nop 0
    v_add_f32_dpp v65, v68, v68 row_ror:4 row_mask:0xf bank_mask:0xf
    v_add_f32_dpp v66, v67, v67 row_ror:4 row_mask:0xf bank_mask:0xf
    s_nop 1
    v_permlane32_swap_b32 v65, v66
    v_cvt_pk_bf16_f32 v65, v65, v65
    v_and_b32 v65, 4294901760, v65
    v_cvt_pk_bf16_f32 v66, v66, v66
    v_and_b32 v66, 4294901760, v66
    v_mul_f32 v65, v65, v6
    v_mul_f32 v66, v66, v7
    v_cvt_pk_bf16_f32 v65, v65, v65
    v_and_b32 v65, 4294901760, v65
    v_cvt_pk_bf16_f32 v66, v66, v66
    v_and_b32 v66, 4294901760, v66
    v_add_f32 v64, v65, v66
    s_nop 1
    v_mov_b32_dpp v65, v64 quad_perm:[1,1,3,3] row_mask:0xf bank_mask:0xf
    v_cvt_pk_bf16_f32 v66, v64, v65
    s_nop 1
    v_mov_b32_dpp v67, v66 quad_perm:[2,2,2,2] row_mask:0xf bank_mask:0xf
    buffer_store_dwordx2 v[66:67], v5, s[60:63], s77 offen sc1
    s_cmp_lg_u32 s2, 0
    s_cbranch_scc1 L_fin
    v_mov_b32 v8, s56
    v_mov_b32 v9, s57
    v_cmp_eq_u32 vcc, 0, v0
    v_mov_b32 v7, 2147483648
    s_nop 0
    v_cndmask_b32 v7, v7, v0, vcc
    buffer_store_dwordx2 v[8:9], v7, s[52:55], 0 offen sc1
L_fin:
L_end:
    s_endpgm
.section .rodata,"a"
.p2align 6
.amdhsa_kernel gated_mix__gqa_block_cached__gqa_block_cached__decode_kernel
  .amdhsa_next_free_vgpr 256
  .amdhsa_next_free_sgpr 102
  .amdhsa_accum_offset 256
  .amdhsa_group_segment_fixed_size 0
  .amdhsa_kernarg_size 112
  .amdhsa_user_sgpr_count 2
  .amdhsa_user_sgpr_kernarg_segment_ptr 1
  .amdhsa_system_sgpr_workgroup_id_x 1
.end_amdhsa_kernel
```
